```python
import torch

def _softmax(x, axis=-1):
    return torch.softmax(x, dim=axis)
def _gelu(x):
    return torch.nn.functional.gelu(x, approximate="tanh")
def _silu(x):
    return torch.nn.functional.silu(x)
def _sigmoid(x):
    return torch.sigmoid(x)
def _layernorm(x, axis=-1, eps=1e-5):
    m = x.mean(dim=axis, keepdim=True)
    v = x.var(dim=axis, keepdim=True, unbiased=False)
    return (x - m) / torch.sqrt(v + eps)
def _scatter_add(tgt, idx, src, axis=0):
    return tgt.clone().index_add_(axis, idx, src)
def _segment_sum(src, seg, n):
    out = torch.zeros((n,) + src.shape[1:], dtype=src.dtype)
    return out.index_add_(0, seg, src)
def _pad(x, pw):
    flat = tuple(v for pair in reversed(pw) for v in pair)
    return torch.nn.functional.pad(x, flat)

kernel_name = 'gated_mix__ssm_conv_s4__dense_activation_mish__prompt'

def setup_inputs():

    _w = (lambda a: (lambda t: t.to(torch.bfloat16) if t.is_floating_point() else t)(torch.as_tensor(a)))
    def _A_setup():
        B, L, D, N = 1, 2048, 512, 128
        A_re = -(lambda _x: torch.exp(torch.as_tensor(_x)))((lambda *s: torch.randn(*s, dtype=torch.bfloat16) * 6.4)(D, N))
        A_im = torch.pi * (lambda *s: torch.randn(*s, dtype=torch.bfloat16) * 0.05)(D, N)
        B_re = (lambda *s: torch.randn(*s, dtype=torch.bfloat16) * 0.1)(D, N)
        B_im = (lambda *s: torch.randn(*s, dtype=torch.bfloat16) * 0.1)(D, N)
        C_re = (lambda *s: torch.randn(*s, dtype=torch.bfloat16) * 0.1)(D, N)
        C_im = (lambda *s: torch.randn(*s, dtype=torch.bfloat16) * 0.1)(D, N)
        log_dt = (lambda *s: torch.randn(*s, dtype=torch.bfloat16) * 0.05)(D) * 0.5 - 4.0
        Dskip = (lambda *s: torch.randn(*s, dtype=torch.bfloat16) * 0.05)(D)
        return {
            "u": _w((lambda *s: torch.randn(*s, dtype=torch.bfloat16) * 0.05)(B, L, D)),
            "A_re": _w(A_re),
            "A_im": _w(A_im),
            "B_re": _w(B_re),
            "B_im": _w(B_im),
            "C_re": _w(C_re),
            "C_im": _w(C_im),
            "log_dt": _w(log_dt),
            "Dskip": _w(Dskip),
        }
    _A_in = _A_setup()

    def _B_setup():
        B, S, D, F = 1, 2048, 512, 1792
        return {
            "x": _w((lambda *s: torch.randn(*s, dtype=torch.bfloat16) * 0.05)(B, S, D)),
            "w1": _w((lambda *s: torch.randn(*s, dtype=torch.bfloat16) * 6.4)(D, F) * (D ** -0.5)),
            "b1": _w((lambda *s: torch.randn(*s, dtype=torch.bfloat16) * 0.05)(F)),
            "w2": _w((lambda *s: torch.randn(*s, dtype=torch.bfloat16) * 0.05)(F, D) * (F ** -0.5)),
        }
    _B_in = _B_setup()

    return {
        "A_u": _A_in["u"],
        "A_A_re": _A_in["A_re"],
        "A_A_im": _A_in["A_im"],
        "A_B_re": _A_in["B_re"],
        "A_B_im": _A_in["B_im"],
        "A_C_re": _A_in["C_re"],
        "A_C_im": _A_in["C_im"],
        "A_log_dt": _A_in["log_dt"],
        "A_Dskip": _A_in["Dskip"],
        "B_x": _B_in["x"],
        "B_w1": _B_in["w1"],
        "B_b1": _B_in["b1"],
        "B_w2": _B_in["w2"],
        "gate_w": _w((lambda *s: torch.randn(*s, dtype=torch.bfloat16) * 0.05)(512) * 16.0),
    }

def reference(A_u, A_A_re, A_A_im, A_B_re, A_B_im, A_C_re, A_C_im, A_log_dt, A_Dskip, B_x, B_w1, B_b1, B_w2, gate_w):
    def _A_ref(u, A_re, A_im, B_re, B_im, C_re, C_im, log_dt, Dskip):
        Bsz, L, D = u.shape
        dt = torch.exp(log_dt)[:, None]
        A = A_re + 1j * A_im
        Bc = B_re + 1j * B_im
        Cc = C_re + 1j * C_im
        logdA = dt * A
        dB = dt * Bc
        l = (lambda x, dt: x.to(dt))(torch.arange(L), A_re.dtype)
        P = torch.exp(logdA[:, :, None] * l[None, None, :])
        K = torch.einsum("dn,dnl,dn->dl", Cc, P, dB).real
        L2 = 2 * L
        Kp = _pad(K, ((0, 0), (0, L)))
        up = (lambda x, *d: x.permute(*d))(u, 0, 2, 1)
        up = _pad(up, ((0, 0), (0, 0), (0, L)))
        Kf = (lambda x, axes=(-2,-1): torch.fft.rfft2(x.float(), dim=axes))(Kp[:, None, :], axes=(-2, -1))
        Uf = (lambda x, axes=(-2,-1): torch.fft.rfft2(x.float(), dim=axes))(up[:, :, None, :], axes=(-2, -1))
        Yf = Uf * Kf[None, :, :, :]
        y = (lambda x, s, axes=(-2,-1): torch.fft.irfft2(x, s=s, dim=axes).to(torch.bfloat16))(Yf, (1, L2), axes=(-2, -1))[:, :, 0, :L]
        y = (lambda x, *d: x.permute(*d))(y, 0, 2, 1) + u * Dskip[None, None, :]
        return y

    def _B_ref(x, w1, b1, w2):
        h = torch.einsum("bsd,df->bsf", x, w1) + b1
        sp = torch.log1p(torch.exp(-torch.abs(h))) + torch.where(h > 0, h, torch.zeros_like(h))
        act = h * torch.tanh(sp)
        return torch.einsum("bsf,fd->bsd", act, w2)

    x = A_u
    g = _sigmoid((x * gate_w).sum(-1, keepdims=True))
    a = _A_ref(x, A_A_re, A_A_im, A_B_re, A_B_im, A_C_re, A_C_im, A_log_dt, A_Dskip)
    b = _B_ref(x, B_w1, B_b1, B_w2)
    return g * a + (1 - g) * b
```

```asm
; @launch grid=(256,1,1) block=(256,1,1) lds=163840
.amdgcn_target "amdgcn-amd-amdhsa--gfx950"
.text
.globl gated_mix__ssm_conv_s4__dense_activation_mish__prompt_kernel
.p2align 8
.type gated_mix__ssm_conv_s4__dense_activation_mish__prompt_kernel,@function
gated_mix__ssm_conv_s4__dense_activation_mish__prompt_kernel:
  s_getpc_b64 s[94:95]
  v_lshlrev_b32 v2, 7, v0
  v_min_u32 v2, Lcode_end-gated_mix__ssm_conv_s4__dense_activation_mish__prompt_kernel-32, v2
  global_load_dword v59, v2, s[94:95]
  s_cmp_ge_u32 s2, 256
  s_cbranch_scc1 Lend
  s_load_dwordx16 s[64:79], s[0:1], 0
  s_load_dwordx4 s[80:83], s[0:1], 80
  s_load_dwordx2 s[20:21], s[0:1], 128
  s_load_dwordx4 s[84:87], s[0:1], 96
  s_load_dwordx2 s[42:43], s[0:1], 64
  s_load_dwordx2 s[22:23], s[0:1], 112
  v_lshrrev_b32 v2, 6, v0
  v_and_b32 v1, 63, v0
  s_and_b32 s45, s2, 7
  v_readfirstlane_b32 s44, v2
  s_lshr_b32 s46, s2, 3
  s_lshr_b32 s53, s45, 1
  s_lshl_b32 s53, s53, 2
  s_and_b32 s54, s46, 3
  s_add_u32 s48, s53, s54
  s_and_b32 s53, s45, 1
  s_mul_i32 s53, s53, 7
  s_lshr_b32 s54, s46, 2
  s_add_u32 s49, s53, s54
  v_lshrrev_b32 v2, 3, v1
  v_and_b32 v3, 7, v1
  v_lshrrev_b32 v4, 4, v1
  v_xor_b32 v3, v3, v4
  v_lshlrev_b32 v3, 4, v3
  v_lshl_add_u32 v20, v2, 10, v3
  v_xor_b32 v5, 64, v20
  v_add_u32 v21, 7168, v5
  v_add_u32 v22, 14336, v20
  v_add_u32 v23, 21504, v5
  v_lshrrev_b32 v2, 2, v1
  v_and_b32 v2, 3, v2
  v_xor_b32 v2, v2, v4
  v_lshlrev_b32 v2, 2, v2
  v_and_b32 v3, 3, v1
  v_or_b32 v2, v2, v3
  v_lshlrev_b32 v2, 4, v2
  v_mul_u32_u24 v3, 3584, v4
  v_add_u32 v24, v2, v3
  v_add_u32 v25, 13312, v24
  v_add_u32 v26, 26624, v24
  v_add_u32 v27, 39936, v24
  s_lshl_b32 s51, s48, 17
  s_lshl_b32 s53, s44, 15
  s_add_u32 s51, s51, s53
  s_mul_i32 s52, s44, 57344
  s_lshl_b32 s53, s49, 8
  s_add_u32 s52, s52, s53
  s_lshl_b32 s50, s44, 12
  s_mov_b32 s10, 0x200000
  s_mov_b32 s11, 0x20000
  s_mov_b32 s14, 0x1c0000
  s_mov_b32 s15, 0x20000
  s_mov_b32 s18, 0x1c0000
  s_mov_b32 s19, 0x20000
  s_lshr_b32 s57, s44, 1
  s_and_b32 s58, s44, 1
  s_mov_b32 s63, 0xb12080
  s_cmp_ge_u32 s46, 28
  s_waitcnt lgkmcnt(0)
  s_mov_b32 s8, s64
  s_mov_b32 s9, s65
  s_mov_b32 s12, s80
  s_mov_b32 s13, s81
  s_mov_b32 s16, s84
  s_mov_b32 s17, s85
  s_cbranch_scc1 Ltrole
  s_lshl_b32 s53, s45, 6
  s_lshl_b32 s54, s46, 1
  s_add_u32 s53, s53, s54
  s_add_u32 s3, s53, s57
  s_lshl_b32 s53, s3, 8
  s_lshl_b32 s54, s58, 7
  s_add_u32 s53, s53, s54
  v_lshlrev_b32 v9, 1, v1
  v_add_u32 v9, s53, v9
  global_load_ushort v10, v9, s[66:67]
  global_load_ushort v11, v9, s[68:69]
  global_load_ushort v12, v9, s[70:71]
  global_load_ushort v13, v9, s[72:73]
  global_load_ushort v14, v9, s[74:75]
  global_load_ushort v15, v9, s[76:77]
  s_lshl_b32 s53, s3, 1
  v_mov_b32 v8, s53
  global_load_ushort v16, v8, s[78:79]
  global_load_ushort v17, v8, s[42:43]
  s_getpc_b64 s[90:91]
Lpc_1:
  s_add_u32 s90, s90, Ltable-Lpc_1
  s_addc_u32 s91, s91, 0
  s_add_u32 m0, s50, 0
  s_add_u32 s55, s51, 0
  buffer_load_dwordx4 v20, s[8:11], s55 offen offset:0 lds
  s_mov_b32 s60, 0x3fb8aa3b
  s_mov_b32 s61, 0x3fb8aa3b
  v_lshrrev_b32 v2, 3, v1
  v_and_b32 v3, 7, v1
  v_lshrrev_b32 v4, 4, v1
  v_and_b32 v4, 1, v4
  v_lshlrev_b32 v4, 2, v4
  v_xor_b32 v3, v3, v4
  v_lshlrev_b32 v3, 4, v3
  v_lshl_add_u32 v28, v2, 10, v3
  v_add_u32 v29, 7168, v28
  s_mul_i32 s92, s44, 458752
  s_and_b32 s53, s45, 1
  s_lshl_b32 s53, s53, 2
  s_and_b32 s54, s46, 3
  s_add_u32 s53, s53, s54
  s_lshl_b32 s53, s53, 7
  s_add_u32 s92, s92, s53
  s_lshl_b32 s93, s44, 13
  v_lshrrev_b32 v2, 5, v1
  buffer_load_dwordx4 v21, s[8:11], s55 offen offset:1024 lds
  v_lshrrev_b32 v3, 2, v1
  v_and_b32 v3, 3, v3
  v_lshl_add_u32 v2, v2, 2, v3
  v_lshlrev_b32 v2, 7, v2
  v_lshrrev_b32 v3, 1, v3
  v_lshl_add_u32 v2, v3, 6, v2
  v_lshrrev_b32 v3, 4, v1
  v_and_b32 v3, 1, v3
  v_lshl_add_u32 v2, v3, 5, v2
  v_and_b32 v3, 3, v1
  v_lshl_add_u32 v2, v3, 3, v2
  v_add_u32 v32, s93, v2
  v_xor_b32 v33, 64, v32
  v_add_u32 v30, 0x10000, v32
  v_add_u32 v31, 0x10000, v33
  v_and_b32 v2, 31, v1
  v_lshrrev_b32 v3, 5, v1
  v_lshrrev_b32 v4, 1, v1
  v_and_b32 v4, 7, v4
  s_lshr_b32 s53, s44, 1
  buffer_load_dwordx4 v22, s[8:11], s55 offen offset:2048 lds
  s_lshl_b32 s53, s53, 13
  v_lshlrev_b32 v2, 7, v2
  v_add_u32 v2, s53, v2
  v_add_u32 v5, 0, v3
  v_xor_b32 v5, v5, v4
  v_lshl_add_u32 v46, v5, 4, v2
  v_add_u32 v50, 0x10000, v46
  v_add_u32 v5, 2, v3
  v_xor_b32 v5, v5, v4
  v_lshl_add_u32 v47, v5, 4, v2
  v_add_u32 v51, 0x10000, v47
  v_add_u32 v5, 4, v3
  v_xor_b32 v5, v5, v4
  v_lshl_add_u32 v48, v5, 4, v2
  v_add_u32 v52, 0x10000, v48
  v_add_u32 v5, 6, v3
  v_xor_b32 v5, v5, v4
  v_lshl_add_u32 v49, v5, 4, v2
  v_add_u32 v53, 0x10000, v49
  v_lshrrev_b32 v4, 2, v1
  buffer_load_dwordx4 v23, s[8:11], s55 offen offset:3072 lds
  v_and_b32 v4, 3, v4
  v_lshl_add_u32 v5, v3, 3, v4
  v_lshlrev_b32 v5, 8, v5
  v_lshrrev_b32 v6, 4, v1
  v_and_b32 v6, 1, v6
  v_lshl_add_u32 v5, v6, 5, v5
  v_and_b32 v6, 3, v1
  v_lshl_add_u32 v5, v6, 3, v5
  v_add_u32 v5, 16384, v5
  s_and_b32 s53, s44, 1
  s_lshl_b32 s53, s53, 1
  v_xor_b32 v6, s53, v4
  v_lshl_add_u32 v54, v6, 6, v5
  v_xor_b32 v55, 64, v54
  v_add_u32 v56, 0x10000, v54
  v_add_u32 v57, 0x10000, v55
  v_cmp_gt_u32 vcc, 32, v1
  v_mov_b32 v2, 0x3f80
  v_mov_b32 v35, 0
  v_mov_b32 v39, 0
  s_add_u32 m0, s50, 16384
  s_add_u32 s55, s52, 0
  buffer_load_dwordx4 v24, s[12:15], s55 offen offset:0 lds
  v_mov_b32 v43, 0
  v_mov_b32 v36, 0
  v_mov_b32 v40, 0
  v_mov_b32 v44, 0
  v_mov_b32 v37, 0
  v_mov_b32 v41, 0
  v_mov_b32 v45, 0
  v_cndmask_b32 v34, 0, v2, vcc
  v_and_b32 v2, 15, v1
  v_lshrrev_b32 v3, 4, v1
  v_mul_u32_u24 v4, 544, v2
  v_lshl_add_u32 v4, v3, 4, v4
  s_mul_i32 s53, s57, 28832
  s_add_u32 s53, s53, 98304
  v_add_u32 v233, s53, v4
  s_mul_i32 s54, s58, 8704
  v_add_u32 v232, s54, v233
  v_mov_b32 v234, 8
  v_mov_b32 v235, v2
  v_cmp_lt_u32 vcc, 7, v2
  buffer_load_dwordx4 v25, s[12:15], s55 offen offset:1024 lds
  v_add_u32 v6, 248, v2
  v_cndmask_b32 v234, v234, 4, vcc
  v_cndmask_b32 v235, v235, v6, vcc
  v_cmp_lt_u32 vcc, 11, v2
  v_add_u32 v6, 372, v2
  s_nop 0
  v_cndmask_b32 v234, v234, 2, vcc
  v_cndmask_b32 v235, v235, v6, vcc
  v_cmp_lt_u32 vcc, 13, v2
  v_add_u32 v6, 434, v2
  s_nop 0
  v_cndmask_b32 v235, v235, v6, vcc
  v_lshlrev_b32 v6, 5, v2
  v_add_u32 v237, 512, v6
  v_mov_b32 v236, 1
  v_cmp_lt_u32 vcc, 3, v2
  s_nop 1
  v_cndmask_b32 v236, v236, 8, vcc
  v_cmp_lt_u32 vcc, 4, v2
  v_mov_b32 v6, 700
  s_nop 0
  v_cndmask_b32 v237, v237, v6, vcc
  v_cndmask_b32 v236, v236, 0, vcc
  s_lshl_b32 s54, s58, 4
  buffer_load_dwordx4 v26, s[12:15], s55 offen offset:2048 lds
  v_lshlrev_b32 v6, 2, v3
  v_add_u32 v6, s54, v6
  s_lshl_b32 s53, s57, 11
  s_add_u32 s53, s53, 155972
  v_mad_u32_u24 v235, v234, v6, v235
  v_lshlrev_b32 v235, 1, v235
  v_add_u32 v235, s53, v235
  v_lshlrev_b32 v234, 1, v234
  v_mad_u32_u24 v237, v236, v6, v237
  v_lshlrev_b32 v237, 1, v237
  v_add_u32 v237, s53, v237
  v_lshlrev_b32 v236, 1, v236
  s_sub_u32 s53, s53, 4
  v_mov_b32 v239, s53
  v_sub_u32 v6, 577, v1
  v_lshrrev_b32 v6, 1, v6
  v_lshl_add_u32 v240, v6, 2, v239
  v_sub_u32 v6, 256, v1
  v_lshl_add_u32 v241, v6, 2, v239
  v_and_b32 v6, 1, v1
  buffer_load_dwordx4 v27, s[12:15], s55 offen offset:3072 lds
  v_cmp_eq_u32 vcc, 1, v6
  s_mov_b32 s67, 0x3020302
  s_mov_b32 s69, 0x1000100
  s_mov_b32 s53, 0x3020504
  s_cmp_eq_u32 s58, 0
  s_cselect_b32 s66, 0x5040504, s53
  s_cselect_b32 s68, 0x1000302, s69
  v_mov_b32 v6, s66
  v_mov_b32 v7, s68
  v_cndmask_b32 v243, v6, v7, vcc
  v_mov_b32 v6, 0x5040504
  v_mov_b32 v7, 0x3020302
  v_cndmask_b32 v242, v6, v7, vcc
  v_mov_b32 v6, 0x1000100
  v_cndmask_b32 v244, v7, v6, vcc
  s_lshl_b32 s54, s57, 1
  s_add_u32 s54, s54, s58
  s_mul_i32 s54, s54, 4160
  s_add_u32 s54, s54, 98304
  v_lshlrev_b32 v6, 4, v1
  v_add_u32 v238, s54, v6
  v_min_u32 v6, 1, v1
  v_lshlrev_b32 v6, 4, v6
  v_add_u32 v245, s54, v6
  s_waitcnt vmcnt(15)
  v_lshlrev_b32 v10, 16, v10
  s_waitcnt vmcnt(14)
  v_lshlrev_b32 v11, 16, v11
  s_waitcnt vmcnt(13)
  v_lshlrev_b32 v12, 16, v12
  s_waitcnt vmcnt(12)
  v_lshlrev_b32 v13, 16, v13
  s_waitcnt vmcnt(11)
  v_lshlrev_b32 v14, 16, v14
  s_waitcnt vmcnt(10)
  v_lshlrev_b32 v15, 16, v15
  s_waitcnt vmcnt(9)
  v_lshlrev_b32 v16, 16, v16
  s_waitcnt vmcnt(8)
  v_lshlrev_b32 v17, 16, v17
  v_mul_f32 v2, s60, v16
  v_mov_b32 v4, 0x32a57060
  v_fma_f32 v3, v16, s60, -v2
  v_exp_f32 v2, v2
  v_fmac_f32 v3, v16, v4
  v_mul_f32 v3, 0x3f317218, v3
  v_fma_f32 v2, v2, v3, v2
  v_cvt_pk_bf16_f32 v2, v2, v2
  v_lshlrev_b32 v2, 16, v2
  v_mul_f32 v10, v2, v10
  v_mul_f32 v11, v2, v11
  v_mul_f32 v12, v2, v12
  v_mul_f32 v13, v2, v13
  v_mul_f32 v10, s60, v10
  v_mul_f32 v11, 0x3e22f983, v11
  v_mul_f32 v64, v14, v12
  v_mul_f32 v65, v14, v13
  v_fma_f32 v64, -v15, v13, v64
  v_fma_f32 v65, v15, v12, v65
  s_lshr_b32 s59, s46, 2
  s_lshl_b32 s59, s59, 2
  s_add_u32 s59, s59, s44
  s_mul_i32 s59, s59, 28
  v_min_u32 v8, 27, v1
  v_add_u32 v8, s59, v8
  v_min_u32 v8, 767, v8
  v_lshrrev_b32 v9, 7, v8
  v_and_b32 v8, 127, v8
  v_lshlrev_b32 v9, 7, v9
  v_lshl_add_u32 v8, v8, 10, v9
  s_lshl_b32 s59, s48, 17
  s_add_u32 s59, s59, 256
  v_add_u32 v8, s59, v8
  global_load_dword v59, v8, s[64:65]
  s_and_b32 s59, s46, 3
  s_lshl_b32 s59, s59, 2
  s_add_u32 s59, s59, s44
  s_mul_i32 s59, s59, 24
  s_add_u32 s59, s59, 128
  s_mul_i32 s59, s59, 3584
  s_lshl_b32 s56, s49, 8
  s_add_u32 s59, s59, s56
  v_min_u32 v8, 47, v1
  v_lshrrev_b32 v9, 1, v8
  v_mul_u32_u24 v9, 3584, v9
  v_and_b32 v8, 1, v8
  v_lshl_add_u32 v8, v8, 7, v9
  v_add_u32 v8, s59, v8
  global_load_dword v59, v8, s[80:81]
  v_mul_f32 v3, 0x41000000, v11
  v_mul_f32 v2, 0x41000000, v10
  v_mul_f32 v113, 0x3f800000, v11
  v_mul_f32 v112, 0x3f800000, v10
  v_mul_f32 v117, 0x43800000, v11
  v_mul_f32 v116, 0x43800000, v10
  v_fract_f32 v3, v3
  v_exp_f32 v2, v2
  v_fract_f32 v113, v113
  v_exp_f32 v112, v112
  v_fract_f32 v117, v117
  v_exp_f32 v116, v116
  v_cos_f32 v4, v3
  v_sin_f32 v5, v3
  v_cos_f32 v114, v113
  v_sin_f32 v115, v113
  v_cos_f32 v118, v117
  v_sin_f32 v119, v117
  v_mul_f32 v68, v2, v4
  v_mul_f32 v69, v2, v5
  v_mul_f32 v66, v112, v114
  v_mul_f32 v67, v112, v115
  v_mul_f32 v70, v116, v118
  v_mul_f32 v71, v116, v119
  s_lshl_b32 s59, s58, 11
  v_lshlrev_b32 v9, 4, v1
  v_add_u32 v9, s59, v9
  global_load_dwordx4 v[224:227], v9, s[90:91]
  s_mul_i32 s53, s57, 28832
  s_lshl_b32 s54, s58, 8
  s_add_u32 s53, s53, s54
  s_add_u32 s53, s53, 98304
  v_lshlrev_b32 v6, 2, v1
  v_add_u32 v6, s53, v6
  v_pk_mul_f32 v[72:73], v[68:69], v[68:69] op_sel:[0,0] op_sel_hi:[0,1]
  v_pk_mul_f32 v[74:75], v[64:65], v[68:69] op_sel:[0,0] op_sel_hi:[0,1]
  v_mov_b32 v86, v64
  v_mov_b32 v87, v65
  v_pk_fma_f32 v[84:85], v[68:69], v[68:69], v[72:73] op_sel:[1,1,0] op_sel_hi:[1,0,1] neg_lo:[0,1,0]
  v_pk_fma_f32 v[90:91], v[64:65], v[68:69], v[74:75] op_sel:[1,1,0] op_sel_hi:[1,0,1] neg_lo:[0,1,0]
  v_mov_b32 v7, 0x3f80
  v_cvt_pk_bf16_f32 v80, v66, -v67
  v_cvt_pk_bf16_f32 v81, v70, -v71
  ds_write_b32 v6, v7 offset:17408
  ds_write_b32 v6, v80 offset:17952
  ds_write_b32 v6, v81 offset:21760
  v_pk_mul_f32 v[72:73], v[86:87], v[84:85] op_sel:[0,0] op_sel_hi:[0,1]
  v_pk_mul_f32 v[74:75], v[90:91], v[84:85] op_sel:[0,0] op_sel_hi:[0,1]
  v_pk_mul_f32 v[76:77], v[66:67], v[66:67] op_sel:[0,0] op_sel_hi:[0,1]
  v_pk_mul_f32 v[78:79], v[70:71], v[70:71] op_sel:[0,0] op_sel_hi:[0,1]
  v_cvt_pk_bf16_f32 v82, v86, v87
  v_cvt_pk_bf16_f32 v83, v90, v91
  v_pk_fma_f32 v[88:89], v[86:87], v[84:85], v[72:73] op_sel:[1,1,0] op_sel_hi:[1,0,1] neg_lo:[0,1,0]
  v_pk_fma_f32 v[92:93], v[90:91], v[84:85], v[74:75] op_sel:[1,1,0] op_sel_hi:[1,0,1] neg_lo:[0,1,0]
  v_pk_fma_f32 v[94:95], v[66:67], v[66:67], v[76:77] op_sel:[1,1,0] op_sel_hi:[1,0,1] neg_lo:[0,1,0]
  v_pk_fma_f32 v[106:107], v[70:71], v[70:71], v[78:79] op_sel:[1,1,0] op_sel_hi:[1,0,1] neg_lo:[0,1,0]
  global_load_dwordx4 v[228:231], v9, s[90:91] offset:1024
  v_pk_mul_f32 v[72:73], v[88:89], v[84:85] op_sel:[0,0] op_sel_hi:[0,1]
  v_pk_mul_f32 v[74:75], v[92:93], v[84:85] op_sel:[0,0] op_sel_hi:[0,1]
  v_pk_mul_f32 v[76:77], v[94:95], v[66:67] op_sel:[0,0] op_sel_hi:[0,1]
  v_pk_mul_f32 v[78:79], v[94:95], v[94:95] op_sel:[0,0] op_sel_hi:[0,1]
  v_cvt_pk_bf16_f32 v120, v88, v89
  v_cvt_pk_bf16_f32 v121, v92, v93
  ds_write_b32 v6, v82 offset:0
  v_cvt_pk_bf16_f32 v122, v94, -v95
  v_cvt_pk_bf16_f32 v123, v106, -v107
  v_pk_fma_f32 v[86:87], v[88:89], v[84:85], v[72:73] op_sel:[1,1,0] op_sel_hi:[1,0,1] neg_lo:[0,1,0]
  v_pk_fma_f32 v[90:91], v[92:93], v[84:85], v[74:75] op_sel:[1,1,0] op_sel_hi:[1,0,1] neg_lo:[0,1,0]
  v_pk_fma_f32 v[96:97], v[94:95], v[66:67], v[76:77] op_sel:[1,1,0] op_sel_hi:[1,0,1] neg_lo:[0,1,0]
  v_pk_fma_f32 v[98:99], v[94:95], v[94:95], v[78:79] op_sel:[1,1,0] op_sel_hi:[1,0,1] neg_lo:[0,1,0]
  ds_write_b32 v6, v83 offset:544
  s_add_u32 m0, s50, 32768
  s_add_u32 s55, s51, 128
  buffer_load_dwordx4 v20, s[8:11], s55 offen offset:0 lds
  v_pk_mul_f32 v[72:73], v[86:87], v[84:85] op_sel:[0,0] op_sel_hi:[0,1]
  v_pk_mul_f32 v[74:75], v[90:91], v[84:85] op_sel:[0,0] op_sel_hi:[0,1]
  ds_write_b32 v6, v120 offset:1088
  v_pk_mul_f32 v[76:77], v[106:107], v[70:71] op_sel:[0,0] op_sel_hi:[0,1]
  v_cvt_pk_bf16_f32 v80, v86, v87
  ds_write_b32 v6, v121 offset:1632
  v_cvt_pk_bf16_f32 v81, v90, v91
  v_cvt_pk_bf16_f32 v82, v96, -v97
  ds_write_b32 v6, v122 offset:18496
  v_cvt_pk_bf16_f32 v83, v98, -v99
  v_pk_fma_f32 v[88:89], v[86:87], v[84:85], v[72:73] op_sel:[1,1,0] op_sel_hi:[1,0,1] neg_lo:[0,1,0]
  ds_write_b32 v6, v123 offset:23936
  v_pk_fma_f32 v[92:93], v[90:91], v[84:85], v[74:75] op_sel:[1,1,0] op_sel_hi:[1,0,1] neg_lo:[0,1,0]
  v_pk_fma_f32 v[108:109], v[106:107], v[70:71], v[76:77] op_sel:[1,1,0] op_sel_hi:[1,0,1] neg_lo:[0,1,0]
  buffer_load_dwordx4 v21, s[8:11], s55 offen offset:1024 lds
  v_pk_mul_f32 v[72:73], v[88:89], v[84:85] op_sel:[0,0] op_sel_hi:[0,1]
  v_pk_mul_f32 v[74:75], v[92:93], v[84:85] op_sel:[0,0] op_sel_hi:[0,1]
  ds_write_b32 v6, v80 offset:2176
  v_pk_mul_f32 v[76:77], v[98:99], v[66:67] op_sel:[0,0] op_sel_hi:[0,1]
  v_cvt_pk_bf16_f32 v120, v88, v89
  ds_write_b32 v6, v81 offset:2720
  v_cvt_pk_bf16_f32 v121, v92, v93
  v_cvt_pk_bf16_f32 v122, v108, -v109
  ds_write_b32 v6, v82 offset:19040
  v_pk_fma_f32 v[86:87], v[88:89], v[84:85], v[72:73] op_sel:[1,1,0] op_sel_hi:[1,0,1] neg_lo:[0,1,0]
  v_pk_fma_f32 v[90:91], v[92:93], v[84:85], v[74:75] op_sel:[1,1,0] op_sel_hi:[1,0,1] neg_lo:[0,1,0]
  ds_write_b32 v6, v83 offset:19584
  v_pk_fma_f32 v[100:101], v[98:99], v[66:67], v[76:77] op_sel:[1,1,0] op_sel_hi:[1,0,1] neg_lo:[0,1,0]
  buffer_load_dwordx4 v22, s[8:11], s55 offen offset:2048 lds
  v_pk_mul_f32 v[72:73], v[86:87], v[84:85] op_sel:[0,0] op_sel_hi:[0,1]
  v_pk_mul_f32 v[74:75], v[90:91], v[84:85] op_sel:[0,0] op_sel_hi:[0,1]
  v_pk_mul_f32 v[76:77], v[98:99], v[94:95] op_sel:[0,0] op_sel_hi:[0,1]
  ds_write_b32 v6, v120 offset:3264
  v_cvt_pk_bf16_f32 v123, v86, v87
  v_cvt_pk_bf16_f32 v80, v90, v91
  v_cvt_pk_bf16_f32 v81, v100, -v101
  ds_write_b32 v6, v121 offset:3808
  v_pk_fma_f32 v[88:89], v[86:87], v[84:85], v[72:73] op_sel:[1,1,0] op_sel_hi:[1,0,1] neg_lo:[0,1,0]
  v_pk_fma_f32 v[92:93], v[90:91], v[84:85], v[74:75] op_sel:[1,1,0] op_sel_hi:[1,0,1] neg_lo:[0,1,0]
  v_pk_fma_f32 v[102:103], v[98:99], v[94:95], v[76:77] op_sel:[1,1,0] op_sel_hi:[1,0,1] neg_lo:[0,1,0]
  ds_write_b32 v6, v122 offset:25024
  v_pk_mul_f32 v[72:73], v[88:89], v[84:85] op_sel:[0,0] op_sel_hi:[0,1]
  v_pk_mul_f32 v[74:75], v[92:93], v[84:85] op_sel:[0,0] op_sel_hi:[0,1]
  v_pk_mul_f32 v[76:77], v[106:107], v[106:107] op_sel:[0,0] op_sel_hi:[0,1]
  ds_write_b32 v6, v123 offset:4352
  v_cvt_pk_bf16_f32 v82, v88, v89
  v_cvt_pk_bf16_f32 v83, v92, v93
  v_cvt_pk_bf16_f32 v120, v102, -v103
  ds_write_b32 v6, v80 offset:4896
  v_pk_fma_f32 v[86:87], v[88:89], v[84:85], v[72:73] op_sel:[1,1,0] op_sel_hi:[1,0,1] neg_lo:[0,1,0]
  v_pk_fma_f32 v[90:91], v[92:93], v[84:85], v[74:75] op_sel:[1,1,0] op_sel_hi:[1,0,1] neg_lo:[0,1,0]
  v_pk_fma_f32 v[110:111], v[106:107], v[106:107], v[76:77] op_sel:[1,1,0] op_sel_hi:[1,0,1] neg_lo:[0,1,0]
  ds_write_b32 v6, v81 offset:20128
  buffer_load_dwordx4 v23, s[8:11], s55 offen offset:3072 lds
  v_pk_mul_f32 v[72:73], v[86:87], v[84:85] op_sel:[0,0] op_sel_hi:[0,1]
  v_pk_mul_f32 v[74:75], v[90:91], v[84:85] op_sel:[0,0] op_sel_hi:[0,1]
  v_pk_mul_f32 v[76:77], v[98:99], v[96:97] op_sel:[0,0] op_sel_hi:[0,1]
  ds_write_b32 v6, v82 offset:5440
  v_cvt_pk_bf16_f32 v121, v86, v87
  v_cvt_pk_bf16_f32 v122, v90, v91
  v_cvt_pk_bf16_f32 v123, v110, -v111
  ds_write_b32 v6, v83 offset:5984
  v_pk_fma_f32 v[88:89], v[86:87], v[84:85], v[72:73] op_sel:[1,1,0] op_sel_hi:[1,0,1] neg_lo:[0,1,0]
  v_pk_fma_f32 v[92:93], v[90:91], v[84:85], v[74:75] op_sel:[1,1,0] op_sel_hi:[1,0,1] neg_lo:[0,1,0]
  v_pk_fma_f32 v[104:105], v[98:99], v[96:97], v[76:77] op_sel:[1,1,0] op_sel_hi:[1,0,1] neg_lo:[0,1,0]
  ds_write_b32 v6, v120 offset:20672
  v_pk_mul_f32 v[72:73], v[88:89], v[84:85] op_sel:[0,0] op_sel_hi:[0,1]
  v_pk_mul_f32 v[74:75], v[92:93], v[84:85] op_sel:[0,0] op_sel_hi:[0,1]
  v_pk_mul_f32 v[76:77], v[70:71], v[94:95] op_sel:[0,0] op_sel_hi:[0,1]
  ds_write_b32 v6, v121 offset:6528
  v_cvt_pk_bf16_f32 v80, v88, v89
  v_cvt_pk_bf16_f32 v81, v92, v93
  v_cvt_pk_bf16_f32 v82, v104, -v105
  ds_write_b32 v6, v122 offset:7072
  v_pk_fma_f32 v[86:87], v[88:89], v[84:85], v[72:73] op_sel:[1,1,0] op_sel_hi:[1,0,1] neg_lo:[0,1,0]
  v_pk_fma_f32 v[90:91], v[92:93], v[84:85], v[74:75] op_sel:[1,1,0] op_sel_hi:[1,0,1] neg_lo:[0,1,0]
  v_pk_fma_f32 v[112:113], v[70:71], v[94:95], v[76:77] op_sel:[1,1,0] op_sel_hi:[1,0,1] neg_lo:[0,1,0]
  ds_write_b32 v6, v123 offset:26112
  s_add_u32 m0, s50, 49152
  s_add_u32 s55, s52, 229376
  buffer_load_dwordx4 v24, s[12:15], s55 offen offset:0 lds
  v_pk_mul_f32 v[72:73], v[86:87], v[84:85] op_sel:[0,0] op_sel_hi:[0,1]
  v_pk_mul_f32 v[74:75], v[90:91], v[84:85] op_sel:[0,0] op_sel_hi:[0,1]
  v_pk_mul_f32 v[76:77], v[70:71], v[98:99] op_sel:[0,0] op_sel_hi:[0,1]
  ds_write_b32 v6, v80 offset:7616
  v_cvt_pk_bf16_f32 v83, v86, v87
  v_cvt_pk_bf16_f32 v120, v90, v91
  v_cvt_pk_bf16_f32 v121, v112, -v113
  ds_write_b32 v6, v81 offset:8160
  v_pk_fma_f32 v[88:89], v[86:87], v[84:85], v[72:73] op_sel:[1,1,0] op_sel_hi:[1,0,1] neg_lo:[0,1,0]
  v_pk_fma_f32 v[92:93], v[90:91], v[84:85], v[74:75] op_sel:[1,1,0] op_sel_hi:[1,0,1] neg_lo:[0,1,0]
  v_pk_fma_f32 v[114:115], v[70:71], v[98:99], v[76:77] op_sel:[1,1,0] op_sel_hi:[1,0,1] neg_lo:[0,1,0]
  ds_write_b32 v6, v82 offset:21216
  v_pk_mul_f32 v[72:73], v[88:89], v[84:85] op_sel:[0,0] op_sel_hi:[0,1]
  v_pk_mul_f32 v[74:75], v[92:93], v[84:85] op_sel:[0,0] op_sel_hi:[0,1]
  v_pk_mul_f32 v[76:77], v[70:71], v[102:103] op_sel:[0,0] op_sel_hi:[0,1]
  ds_write_b32 v6, v83 offset:8704
  v_cvt_pk_bf16_f32 v122, v88, v89
  v_cvt_pk_bf16_f32 v123, v92, v93
  v_cvt_pk_bf16_f32 v80, v114, -v115
  ds_write_b32 v6, v120 offset:9248
  v_pk_fma_f32 v[86:87], v[88:89], v[84:85], v[72:73] op_sel:[1,1,0] op_sel_hi:[1,0,1] neg_lo:[0,1,0]
  v_pk_fma_f32 v[90:91], v[92:93], v[84:85], v[74:75] op_sel:[1,1,0] op_sel_hi:[1,0,1] neg_lo:[0,1,0]
  v_pk_fma_f32 v[112:113], v[70:71], v[102:103], v[76:77] op_sel:[1,1,0] op_sel_hi:[1,0,1] neg_lo:[0,1,0]
  ds_write_b32 v6, v121 offset:22304
  buffer_load_dwordx4 v25, s[12:15], s55 offen offset:1024 lds
  v_pk_mul_f32 v[72:73], v[86:87], v[84:85] op_sel:[0,0] op_sel_hi:[0,1]
  v_pk_mul_f32 v[74:75], v[90:91], v[84:85] op_sel:[0,0] op_sel_hi:[0,1]
  v_pk_mul_f32 v[76:77], v[106:107], v[98:99] op_sel:[0,0] op_sel_hi:[0,1]
  ds_write_b32 v6, v122 offset:9792
  v_cvt_pk_bf16_f32 v81, v86, v87
  v_cvt_pk_bf16_f32 v82, v90, v91
  v_cvt_pk_bf16_f32 v83, v112, -v113
  ds_write_b32 v6, v123 offset:10336
  v_pk_fma_f32 v[88:89], v[86:87], v[84:85], v[72:73] op_sel:[1,1,0] op_sel_hi:[1,0,1] neg_lo:[0,1,0]
  v_pk_fma_f32 v[92:93], v[90:91], v[84:85], v[74:75] op_sel:[1,1,0] op_sel_hi:[1,0,1] neg_lo:[0,1,0]
  v_pk_fma_f32 v[114:115], v[106:107], v[98:99], v[76:77] op_sel:[1,1,0] op_sel_hi:[1,0,1] neg_lo:[0,1,0]
  ds_write_b32 v6, v80 offset:22848
  v_pk_mul_f32 v[72:73], v[88:89], v[84:85] op_sel:[0,0] op_sel_hi:[0,1]
  v_pk_mul_f32 v[74:75], v[92:93], v[84:85] op_sel:[0,0] op_sel_hi:[0,1]
  v_pk_mul_f32 v[76:77], v[108:109], v[98:99] op_sel:[0,0] op_sel_hi:[0,1]
  ds_write_b32 v6, v81 offset:10880
  v_cvt_pk_bf16_f32 v120, v88, v89
  v_cvt_pk_bf16_f32 v121, v92, v93
  v_cvt_pk_bf16_f32 v122, v114, -v115
  ds_write_b32 v6, v82 offset:11424
  v_pk_fma_f32 v[86:87], v[88:89], v[84:85], v[72:73] op_sel:[1,1,0] op_sel_hi:[1,0,1] neg_lo:[0,1,0]
  v_pk_fma_f32 v[90:91], v[92:93], v[84:85], v[74:75] op_sel:[1,1,0] op_sel_hi:[1,0,1] neg_lo:[0,1,0]
  v_pk_fma_f32 v[112:113], v[108:109], v[98:99], v[76:77] op_sel:[1,1,0] op_sel_hi:[1,0,1] neg_lo:[0,1,0]
  ds_write_b32 v6, v83 offset:23392
  buffer_load_dwordx4 v26, s[12:15], s55 offen offset:2048 lds
  v_pk_mul_f32 v[72:73], v[86:87], v[84:85] op_sel:[0,0] op_sel_hi:[0,1]
  v_pk_mul_f32 v[74:75], v[90:91], v[84:85] op_sel:[0,0] op_sel_hi:[0,1]
  v_pk_mul_f32 v[76:77], v[110:111], v[70:71] op_sel:[0,0] op_sel_hi:[0,1]
  ds_write_b32 v6, v120 offset:11968
  v_cvt_pk_bf16_f32 v123, v86, v87
  v_cvt_pk_bf16_f32 v80, v90, v91
  v_cvt_pk_bf16_f32 v81, v112, -v113
  ds_write_b32 v6, v121 offset:12512
  v_pk_fma_f32 v[88:89], v[86:87], v[84:85], v[72:73] op_sel:[1,1,0] op_sel_hi:[1,0,1] neg_lo:[0,1,0]
  v_pk_fma_f32 v[92:93], v[90:91], v[84:85], v[74:75] op_sel:[1,1,0] op_sel_hi:[1,0,1] neg_lo:[0,1,0]
  v_pk_fma_f32 v[114:115], v[110:111], v[70:71], v[76:77] op_sel:[1,1,0] op_sel_hi:[1,0,1] neg_lo:[0,1,0]
  ds_write_b32 v6, v122 offset:24480
  v_pk_mul_f32 v[72:73], v[88:89], v[84:85] op_sel:[0,0] op_sel_hi:[0,1]
  v_pk_mul_f32 v[74:75], v[92:93], v[84:85] op_sel:[0,0] op_sel_hi:[0,1]
  v_pk_mul_f32 v[76:77], v[110:111], v[106:107] op_sel:[0,0] op_sel_hi:[0,1]
  ds_write_b32 v6, v123 offset:13056
  v_cvt_pk_bf16_f32 v82, v88, v89
  v_cvt_pk_bf16_f32 v83, v92, v93
  v_cvt_pk_bf16_f32 v120, v114, -v115
  ds_write_b32 v6, v80 offset:13600
  v_pk_fma_f32 v[86:87], v[88:89], v[84:85], v[72:73] op_sel:[1,1,0] op_sel_hi:[1,0,1] neg_lo:[0,1,0]
  v_pk_fma_f32 v[90:91], v[92:93], v[84:85], v[74:75] op_sel:[1,1,0] op_sel_hi:[1,0,1] neg_lo:[0,1,0]
  v_pk_fma_f32 v[112:113], v[110:111], v[106:107], v[76:77] op_sel:[1,1,0] op_sel_hi:[1,0,1] neg_lo:[0,1,0]
  ds_write_b32 v6, v81 offset:25568
  buffer_load_dwordx4 v27, s[12:15], s55 offen offset:3072 lds
  v_pk_mul_f32 v[72:73], v[86:87], v[84:85] op_sel:[0,0] op_sel_hi:[0,1]
  v_pk_mul_f32 v[74:75], v[90:91], v[84:85] op_sel:[0,0] op_sel_hi:[0,1]
  v_pk_mul_f32 v[76:77], v[110:111], v[108:109] op_sel:[0,0] op_sel_hi:[0,1]
  ds_write_b32 v6, v82 offset:14144
  v_cvt_pk_bf16_f32 v121, v86, v87
  v_cvt_pk_bf16_f32 v122, v90, v91
  v_cvt_pk_bf16_f32 v123, v112, -v113
  ds_write_b32 v6, v83 offset:14688
  v_pk_fma_f32 v[88:89], v[86:87], v[84:85], v[72:73] op_sel:[1,1,0] op_sel_hi:[1,0,1] neg_lo:[0,1,0]
  v_pk_fma_f32 v[92:93], v[90:91], v[84:85], v[74:75] op_sel:[1,1,0] op_sel_hi:[1,0,1] neg_lo:[0,1,0]
  v_pk_fma_f32 v[114:115], v[110:111], v[108:109], v[76:77] op_sel:[1,1,0] op_sel_hi:[1,0,1] neg_lo:[0,1,0]
  ds_write_b32 v6, v120 offset:26656
  v_pk_mul_f32 v[72:73], v[110:111], v[110:111] op_sel:[0,0] op_sel_hi:[0,1]
  ds_write_b32 v6, v121 offset:15232
  v_cvt_pk_bf16_f32 v80, v88, v89
  ds_write_b32 v6, v122 offset:15776
  v_cvt_pk_bf16_f32 v81, v92, v93
  ds_write_b32 v6, v123 offset:27200
  v_cvt_pk_bf16_f32 v82, v114, -v115
  v_pk_fma_f32 v[112:113], v[110:111], v[110:111], v[72:73] op_sel:[1,1,0] op_sel_hi:[1,0,1] neg_lo:[0,1,0]
  v_cvt_pk_bf16_f32 v83, v112, -v113
  ds_write_b32 v6, v80 offset:16320
  ds_write_b32 v6, v81 offset:16864
  ds_write_b32 v6, v82 offset:27744
  ds_write_b32 v6, v83 offset:28288
  s_waitcnt vmcnt(12)
  s_waitcnt lgkmcnt(0)
  s_barrier
  ds_read_b64_tr_b16 v[128:129], v54 offset:0
  ds_read_b64_tr_b16 v[130:131], v54 offset:1024
  ds_read_b128 v[136:139], v46 offset:0
  ds_read_b128 v[140:143], v46 offset:4096
  ds_read_b64_tr_b16 v[132:133], v55 offset:0
  ds_read_b64_tr_b16 v[134:135], v55 offset:1024
  s_waitcnt lgkmcnt(3)
  v_mfma_f32_32x32x16_bf16 v[64:79], v[128:131], v[136:139], 0
  ds_read_b64_tr_b16 v[144:145], v54 offset:4096
  ds_read_b64_tr_b16 v[146:147], v54 offset:5120
  ds_read_b128 v[160:163], v232 offset:0
  ds_read_b128 v[176:179], v233 offset:17408
  ds_read_b128 v[180:183], v233 offset:26112
  s_waitcnt lgkmcnt(7)
  v_mfma_f32_32x32x16_bf16 v[80:95], v[128:131], v[140:143], 0
  ds_read_b128 v[152:155], v47 offset:0
  ds_read_b128 v[156:159], v47 offset:4096
  s_add_u32 m0, s50, 65536
  s_add_u32 s55, s51, 256
  buffer_load_dwordx4 v20, s[8:11], s55 offen offset:0 lds
  ds_read_b128 v[164:167], v232 offset:64
  ds_read_b128 v[184:187], v233 offset:17472
  ds_read_b128 v[188:191], v233 offset:26176
  s_waitcnt lgkmcnt(10)
  v_mfma_f32_32x32x16_bf16 v[96:111], v[132:135], v[136:139], 0
  ds_read_b64_tr_b16 v[148:149], v55 offset:4096
  ds_read_b64_tr_b16 v[150:151], v55 offset:5120
  buffer_load_dwordx4 v21, s[8:11], s55 offen offset:1024 lds
  ds_read_b128 v[168:171], v232 offset:128
  ds_read_b128 v[192:195], v233 offset:17536
  ds_read_b128 v[196:199], v233 offset:26240
  v_mfma_f32_32x32x16_bf16 v[112:127], v[132:135], v[140:143], 0
  ds_read_b128 v[172:175], v232 offset:192
  ds_read_b128 v[200:203], v233 offset:17600
  ds_read_b128 v[204:207], v233 offset:26304
  s_waitcnt vmcnt(11)
  v_add_u32 v224, v239, v224
  s_waitcnt lgkmcnt(12)
  v_mfma_f32_32x32x16_bf16 v[64:79], v[144:147], v[152:155], v[64:79]
  ds_read_b64_tr_b16 v[128:129], v54 offset:8192
  ds_read_b64_tr_b16 v[130:131], v54 offset:9216
  v_add_u32 v225, v239, v225
  v_add_u32 v226, v239, v226
  v_add_u32 v227, v239, v227
  s_waitcnt lgkmcnt(13)
  v_mfma_f32_32x32x16_bf16 v[80:95], v[144:147], v[156:159], v[80:95]
  ds_read_b128 v[136:139], v48 offset:0
  ds_read_b128 v[140:143], v48 offset:4096
  buffer_load_dwordx4 v22, s[8:11], s55 offen offset:2048 lds
  v_mov_b32 v220, 0
  v_mov_b32 v221, 0
  v_mov_b32 v222, 0
  s_waitcnt lgkmcnt(10)
  v_mfma_f32_32x32x16_bf16 v[96:111], v[148:151], v[152:155], v[96:111]
  ds_read_b64_tr_b16 v[132:133], v55 offset:8192
  ds_read_b64_tr_b16 v[134:135], v55 offset:9216
  buffer_load_dwordx4 v23, s[8:11], s55 offen offset:3072 lds
  v_mov_b32 v223, 0
  v_mfma_f32_16x16x32_bf16 v[208:211], v[160:163], v[176:179], 0
  v_mfma_f32_16x16x32_bf16 v[212:215], v[160:163], v[180:183], 0
  v_mfma_f32_32x32x16_bf16 v[112:127], v[148:151], v[156:159], v[112:127]
  v_mfma_f32_16x16x32_bf16 v[208:211], v[164:167], v[184:187], v[208:211]
  v_mfma_f32_16x16x32_bf16 v[212:215], v[164:167], v[188:191], v[212:215]
  s_waitcnt lgkmcnt(10)
  v_mfma_f32_16x16x32_bf16 v[208:211], v[168:171], v[192:195], v[208:211]
  s_waitcnt lgkmcnt(9)
  v_mfma_f32_16x16x32_bf16 v[212:215], v[168:171], v[196:199], v[212:215]
  s_waitcnt lgkmcnt(3)
  v_mfma_f32_32x32x16_bf16 v[64:79], v[128:131], v[136:139], v[64:79]
  ds_read_b64_tr_b16 v[144:145], v54 offset:12288
  ds_read_b64_tr_b16 v[146:147], v54 offset:13312
  v_mfma_f32_16x16x32_bf16 v[208:211], v[172:175], v[200:203], v[208:211]
  v_mfma_f32_16x16x32_bf16 v[212:215], v[172:175], v[204:207], v[212:215]
  ds_read_b128 v[160:163], v232 offset:256
  s_waitcnt lgkmcnt(5)
  v_mfma_f32_32x32x16_bf16 v[80:95], v[128:131], v[140:143], v[80:95]
  ds_read_b128 v[152:155], v49 offset:0
  ds_read_b128 v[156:159], v49 offset:4096
  s_add_u32 m0, s50, 81920
  s_add_u32 s55, s52, 458752
  buffer_load_dwordx4 v24, s[12:15], s55 offen offset:0 lds
  ds_read_b128 v[176:179], v233 offset:17664
  ds_read_b128 v[180:183], v233 offset:26368
  ds_read_b128 v[164:167], v232 offset:320
  s_waitcnt lgkmcnt(8)
  v_mfma_f32_32x32x16_bf16 v[96:111], v[132:135], v[136:139], v[96:111]
  ds_read_b64_tr_b16 v[148:149], v55 offset:12288
  ds_read_b64_tr_b16 v[150:151], v55 offset:13312
  buffer_load_dwordx4 v25, s[12:15], s55 offen offset:1024 lds
  ds_read_b128 v[184:187], v233 offset:17728
  ds_read_b128 v[188:191], v233 offset:26432
  ds_read_b128 v[168:171], v232 offset:384
  v_mfma_f32_32x32x16_bf16 v[112:127], v[132:135], v[140:143], v[112:127]
  buffer_load_dwordx4 v26, s[12:15], s55 offen offset:2048 lds
  buffer_load_dwordx4 v27, s[12:15], s55 offen offset:3072 lds
  ds_read_b128 v[192:195], v233 offset:17792
  ds_read_b128 v[196:199], v233 offset:26496
  ds_read_b128 v[172:175], v232 offset:448
  ds_read_b128 v[200:203], v233 offset:17856
  s_waitcnt lgkmcnt(0)
  s_waitcnt vmcnt(8)
  s_barrier
  v_mfma_f32_32x32x16_bf16 v[64:79], v[144:147], v[152:155], v[64:79]
  ds_read_b64_tr_b16 v[128:129], v54 offset:32768
  ds_read_b64_tr_b16 v[130:131], v54 offset:33792
  ds_read_b128 v[204:207], v233 offset:26560
  v_mfma_f32_16x16x32_bf16 v[208:211], v[160:163], v[176:179], v[208:211]
  v_mfma_f32_16x16x32_bf16 v[212:215], v[160:163], v[180:183], v[212:215]
  v_mfma_f32_32x32x16_bf16 v[80:95], v[144:147], v[156:159], v[80:95]
  ds_read_b128 v[136:139], v46 offset:32768
  ds_read_b128 v[140:143], v46 offset:36864
  v_mfma_f32_16x16x32_bf16 v[208:211], v[164:167], v[184:187], v[208:211]
  v_mfma_f32_16x16x32_bf16 v[212:215], v[164:167], v[188:191], v[212:215]
  v_mfma_f32_16x16x32_bf16 v[208:211], v[168:171], v[192:195], v[208:211]
  v_mfma_f32_32x32x16_bf16 v[96:111], v[148:151], v[152:155], v[96:111]
  ds_read_b64_tr_b16 v[132:133], v55 offset:32768
  ds_read_b64_tr_b16 v[134:135], v55 offset:33792
  v_mfma_f32_16x16x32_bf16 v[212:215], v[168:171], v[196:199], v[212:215]
  v_mfma_f32_16x16x32_bf16 v[208:211], v[172:175], v[200:203], v[208:211]
  s_waitcnt lgkmcnt(4)
  v_mfma_f32_16x16x32_bf16 v[212:215], v[172:175], v[204:207], v[212:215]
  v_mfma_f32_32x32x16_bf16 v[112:127], v[148:151], v[156:159], v[112:127]
  ds_write_b32 v239, v220
  s_nop 3
  v_cvt_pk_bf16_f32 v216, v208, v208
  v_cvt_pk_bf16_f32 v217, v209, v209
  v_cvt_pk_bf16_f32 v218, v210, v210
  s_waitcnt lgkmcnt(4)
  v_mfma_f32_32x32x16_bf16 v[64:79], v[128:131], v[136:139], v[64:79]
  ds_read_b64_tr_b16 v[144:145], v54 offset:36864
  ds_read_b64_tr_b16 v[146:147], v54 offset:37888
  v_cvt_pk_bf16_f32 v219, v211, v211
  ds_write_b16 v235, v216
  v_add_u32 v235, v234, v235
  s_waitcnt lgkmcnt(6)
  v_mfma_f32_32x32x16_bf16 v[80:95], v[128:131], v[140:143], v[80:95]
  ds_read_b128 v[152:155], v47 offset:32768
  ds_read_b128 v[156:159], v47 offset:36864
  s_add_u32 m0, s50, 0
  s_add_u32 s55, s51, 384
  buffer_load_dwordx4 v20, s[8:11], s55 offen offset:0 lds
  ds_write_b16 v235, v217
  v_add_u32 v235, v234, v235
  ds_write_b16 v235, v218
  s_waitcnt lgkmcnt(8)
  v_mfma_f32_32x32x16_bf16 v[96:111], v[132:135], v[136:139], v[96:111]
  ds_read_b64_tr_b16 v[148:149], v55 offset:36864
  ds_read_b64_tr_b16 v[150:151], v55 offset:37888
  buffer_load_dwordx4 v21, s[8:11], s55 offen offset:1024 lds
  v_add_u32 v235, v234, v235
  ds_write_b16 v235, v219
  v_cvt_pk_bf16_f32 v216, v212, v212
  v_mfma_f32_32x32x16_bf16 v[112:127], v[132:135], v[140:143], v[112:127]
  v_cvt_pk_bf16_f32 v217, v213, v213
  v_cvt_pk_bf16_f32 v218, v214, v214
  v_cvt_pk_bf16_f32 v219, v215, v215
  ds_write_b16 v237, v216
  s_waitcnt lgkmcnt(7)
  v_mfma_f32_32x32x16_bf16 v[64:79], v[144:147], v[152:155], v[64:79]
  ds_read_b64_tr_b16 v[128:129], v54 offset:40960
  ds_read_b64_tr_b16 v[130:131], v54 offset:41984
  v_add_u32 v237, v236, v237
  ds_write_b16 v237, v217
  v_add_u32 v237, v236, v237
  s_waitcnt lgkmcnt(9)
  v_mfma_f32_32x32x16_bf16 v[80:95], v[144:147], v[156:159], v[80:95]
  ds_read_b128 v[136:139], v48 offset:32768
  ds_read_b128 v[140:143], v48 offset:36864
  buffer_load_dwordx4 v22, s[8:11], s55 offen offset:2048 lds
  ds_write_b16 v237, v218
  v_add_u32 v237, v236, v237
  ds_write_b16 v237, v219
  s_waitcnt lgkmcnt(9)
  v_mfma_f32_32x32x16_bf16 v[96:111], v[148:151], v[152:155], v[96:111]
  ds_read_b64_tr_b16 v[132:133], v55 offset:40960
  ds_read_b64_tr_b16 v[134:135], v55 offset:41984
  buffer_load_dwordx4 v23, s[8:11], s55 offen offset:3072 lds
  v_mfma_f32_32x32x16_bf16 v[112:127], v[148:151], v[156:159], v[112:127]
  s_waitcnt lgkmcnt(5)
  v_mfma_f32_32x32x16_bf16 v[64:79], v[128:131], v[136:139], v[64:79]
  ds_read_b64_tr_b16 v[144:145], v54 offset:45056
  ds_read_b64_tr_b16 v[146:147], v54 offset:46080
  s_waitcnt lgkmcnt(6)
  v_mfma_f32_32x32x16_bf16 v[80:95], v[128:131], v[140:143], v[80:95]
  ds_read_b128 v[152:155], v49 offset:32768
  ds_read_b128 v[156:159], v49 offset:36864
  s_add_u32 m0, s50, 16384
  s_add_u32 s55, s52, 688128
  buffer_load_dwordx4 v24, s[12:15], s55 offen offset:0 lds
  s_waitcnt lgkmcnt(4)
  v_mfma_f32_32x32x16_bf16 v[96:111], v[132:135], v[136:139], v[96:111]
  ds_read_b64_tr_b16 v[148:149], v55 offset:45056
  ds_read_b64_tr_b16 v[150:151], v55 offset:46080
  buffer_load_dwordx4 v25, s[12:15], s55 offen offset:1024 lds
  v_mfma_f32_32x32x16_bf16 v[112:127], v[132:135], v[140:143], v[112:127]
  buffer_load_dwordx4 v26, s[12:15], s55 offen offset:2048 lds
  buffer_load_dwordx4 v27, s[12:15], s55 offen offset:3072 lds
  s_waitcnt lgkmcnt(0)
  s_waitcnt vmcnt(8)
  s_barrier
  v_mfma_f32_32x32x16_bf16 v[64:79], v[144:147], v[152:155], v[64:79]
  ds_read_b64_tr_b16 v[128:129], v56 offset:0
  ds_read_b64_tr_b16 v[130:131], v56 offset:1024
  ds_read2_b32 v[160:161], v240 offset0:32 offset1:33
  ds_read2_b32 v[162:163], v240 offset0:0 offset1:1
  ds_read2_b32 v[164:165], v241 offset0:0 offset1:1
  v_mfma_f32_32x32x16_bf16 v[80:95], v[144:147], v[156:159], v[80:95]
  ds_read_b128 v[136:139], v50 offset:0
  ds_read_b128 v[140:143], v50 offset:4096
  ds_read2_b32 v[166:167], v224 offset0:0 offset1:1
  ds_read2_b32 v[168:169], v225 offset0:0 offset1:1
  ds_read2_b32 v[170:171], v226 offset0:0 offset1:1
  v_mfma_f32_32x32x16_bf16 v[96:111], v[148:151], v[152:155], v[96:111]
  ds_read_b64_tr_b16 v[132:133], v57 offset:0
  ds_read_b64_tr_b16 v[134:135], v57 offset:1024
  ds_read2_b32 v[172:173], v227 offset0:0 offset1:1
  ds_write_b128 v245, v[220:223] offset:4096
  s_waitcnt lgkmcnt(11)
  v_perm_b32 v176, v161, v160, v242
  v_mfma_f32_32x32x16_bf16 v[112:127], v[148:151], v[156:159], v[112:127]
  v_perm_b32 v177, v161, v160, v243
  v_perm_b32 v178, v161, v160, v244
  v_perm_b32 v179, v161, v160, v244
  ds_write_b128 v238, v[176:179] offset:0
  s_waitcnt lgkmcnt(9)
  v_mfma_f32_32x32x16_bf16 v[64:79], v[128:131], v[136:139], v[64:79]
  ds_read_b64_tr_b16 v[144:145], v56 offset:4096
  ds_read_b64_tr_b16 v[146:147], v56 offset:5120
  v_perm_b32 v180, v163, v162, v242
  v_perm_b32 v181, v163, v162, v243
  v_perm_b32 v182, v163, v162, v244
  s_waitcnt lgkmcnt(10)
  v_mfma_f32_32x32x16_bf16 v[80:95], v[128:131], v[140:143], v[80:95]
  ds_read_b128 v[152:155], v51 offset:0
  ds_read_b128 v[156:159], v51 offset:4096
  s_add_u32 m0, s50, 32768
  s_add_u32 s55, s51, 512
  buffer_load_dwordx4 v20, s[8:11], s55 offen offset:0 lds
  v_perm_b32 v183, v163, v162, v244
  ds_write_b128 v238, v[180:183] offset:1024
  v_perm_b32 v184, v165, v164, s66
  s_waitcnt lgkmcnt(8)
  v_mfma_f32_32x32x16_bf16 v[96:111], v[132:135], v[136:139], v[96:111]
  ds_read_b64_tr_b16 v[148:149], v57 offset:4096
  ds_read_b64_tr_b16 v[150:151], v57 offset:5120
  buffer_load_dwordx4 v21, s[8:11], s55 offen offset:1024 lds
  v_perm_b32 v185, v165, v164, s67
  v_perm_b32 v186, v165, v164, s68
  v_perm_b32 v187, v165, v164, s69
  v_mfma_f32_32x32x16_bf16 v[112:127], v[132:135], v[140:143], v[112:127]
  ds_write_b128 v238, v[184:187] offset:2048
  v_perm_b32 v188, v167, v166, v228
  v_perm_b32 v189, v169, v168, v229
  v_perm_b32 v190, v171, v170, v230
  s_waitcnt lgkmcnt(5)
  v_mfma_f32_32x32x16_bf16 v[64:79], v[144:147], v[152:155], v[64:79]
  ds_read_b64_tr_b16 v[128:129], v56 offset:8192
  ds_read_b64_tr_b16 v[130:131], v56 offset:9216
  v_perm_b32 v191, v173, v172, v231
  ds_write_b128 v238, v[188:191] offset:3072
  s_waitcnt lgkmcnt(7)
  v_mfma_f32_32x32x16_bf16 v[80:95], v[144:147], v[156:159], v[80:95]
  ds_read_b128 v[136:139], v52 offset:0
  ds_read_b128 v[140:143], v52 offset:4096
  buffer_load_dwordx4 v22, s[8:11], s55 offen offset:2048 lds
  s_waitcnt lgkmcnt(6)
  v_mfma_f32_32x32x16_bf16 v[96:111], v[148:151], v[152:155], v[96:111]
  ds_read_b64_tr_b16 v[132:133], v57 offset:8192
  ds_read_b64_tr_b16 v[134:135], v57 offset:9216
  buffer_load_dwordx4 v23, s[8:11], s55 offen offset:3072 lds
  v_mfma_f32_32x32x16_bf16 v[112:127], v[148:151], v[156:159], v[112:127]
  s_waitcnt lgkmcnt(3)
  v_mfma_f32_32x32x16_bf16 v[64:79], v[128:131], v[136:139], v[64:79]
  ds_read_b64_tr_b16 v[144:145], v56 offset:12288
  ds_read_b64_tr_b16 v[146:147], v56 offset:13312
  s_waitcnt lgkmcnt(4)
  v_mfma_f32_32x32x16_bf16 v[80:95], v[128:131], v[140:143], v[80:95]
  ds_read_b128 v[152:155], v53 offset:0
  ds_read_b128 v[156:159], v53 offset:4096
  s_add_u32 m0, s50, 49152
  s_add_u32 s55, s52, 917504
  buffer_load_dwordx4 v24, s[12:15], s55 offen offset:0 lds
  s_waitcnt lgkmcnt(4)
  v_mfma_f32_32x32x16_bf16 v[96:111], v[132:135], v[136:139], v[96:111]
  ds_read_b64_tr_b16 v[148:149], v57 offset:12288
  ds_read_b64_tr_b16 v[150:151], v57 offset:13312
  buffer_load_dwordx4 v25, s[12:15], s55 offen offset:1024 lds
  v_mfma_f32_32x32x16_bf16 v[112:127], v[132:135], v[140:143], v[112:127]
  buffer_load_dwordx4 v26, s[12:15], s55 offen offset:2048 lds
  buffer_load_dwordx4 v27, s[12:15], s55 offen offset:3072 lds
  s_waitcnt lgkmcnt(0)
  s_waitcnt vmcnt(8)
  s_barrier
  v_mfma_f32_32x32x16_bf16 v[64:79], v[144:147], v[152:155], v[64:79]
  ds_read_b64_tr_b16 v[128:129], v54 offset:0
  ds_read_b64_tr_b16 v[130:131], v54 offset:1024
  v_mfma_f32_32x32x16_bf16 v[80:95], v[144:147], v[156:159], v[80:95]
  ds_read_b128 v[136:139], v46 offset:0
  ds_read_b128 v[140:143], v46 offset:4096
  v_mfma_f32_32x32x16_bf16 v[96:111], v[148:151], v[152:155], v[96:111]
  ds_read_b64_tr_b16 v[132:133], v55 offset:0
  ds_read_b64_tr_b16 v[134:135], v55 offset:1024
  v_mfma_f32_32x32x16_bf16 v[112:127], v[148:151], v[156:159], v[112:127]
  s_waitcnt lgkmcnt(3)
  v_mfma_f32_32x32x16_bf16 v[64:79], v[128:131], v[136:139], v[64:79]
  ds_read_b64_tr_b16 v[144:145], v54 offset:4096
  ds_read_b64_tr_b16 v[146:147], v54 offset:5120
  s_waitcnt lgkmcnt(4)
  v_mfma_f32_32x32x16_bf16 v[80:95], v[128:131], v[140:143], v[80:95]
  ds_read_b128 v[152:155], v47 offset:0
  ds_read_b128 v[156:159], v47 offset:4096
  s_add_u32 m0, s50, 65536
  s_add_u32 s55, s51, 640
  buffer_load_dwordx4 v20, s[8:11], s55 offen offset:0 lds
  s_waitcnt lgkmcnt(4)
  v_mfma_f32_32x32x16_bf16 v[96:111], v[132:135], v[136:139], v[96:111]
  ds_read_b64_tr_b16 v[148:149], v55 offset:4096
  ds_read_b64_tr_b16 v[150:151], v55 offset:5120
  buffer_load_dwordx4 v21, s[8:11], s55 offen offset:1024 lds
  v_mfma_f32_32x32x16_bf16 v[112:127], v[132:135], v[140:143], v[112:127]
  s_waitcnt lgkmcnt(3)
  v_mfma_f32_32x32x16_bf16 v[64:79], v[144:147], v[152:155], v[64:79]
  ds_read_b64_tr_b16 v[128:129], v54 offset:8192
  ds_read_b64_tr_b16 v[130:131], v54 offset:9216
  s_waitcnt lgkmcnt(4)
  v_mfma_f32_32x32x16_bf16 v[80:95], v[144:147], v[156:159], v[80:95]
  ds_read_b128 v[136:139], v48 offset:0
  ds_read_b128 v[140:143], v48 offset:4096
  buffer_load_dwordx4 v22, s[8:11], s55 offen offset:2048 lds
  s_waitcnt lgkmcnt(4)
  v_mfma_f32_32x32x16_bf16 v[96:111], v[148:151], v[152:155], v[96:111]
  ds_read_b64_tr_b16 v[132:133], v55 offset:8192
  ds_read_b64_tr_b16 v[134:135], v55 offset:9216
  buffer_load_dwordx4 v23, s[8:11], s55 offen offset:3072 lds
  v_mfma_f32_32x32x16_bf16 v[112:127], v[148:151], v[156:159], v[112:127]
  s_waitcnt lgkmcnt(3)
  v_mfma_f32_32x32x16_bf16 v[64:79], v[128:131], v[136:139], v[64:79]
  ds_read_b64_tr_b16 v[144:145], v54 offset:12288
  ds_read_b64_tr_b16 v[146:147], v54 offset:13312
  s_waitcnt lgkmcnt(4)
  v_mfma_f32_32x32x16_bf16 v[80:95], v[128:131], v[140:143], v[80:95]
  ds_read_b128 v[152:155], v49 offset:0
  ds_read_b128 v[156:159], v49 offset:4096
  s_add_u32 m0, s50, 81920
  s_add_u32 s55, s52, 1146880
  buffer_load_dwordx4 v24, s[12:15], s55 offen offset:0 lds
  s_waitcnt lgkmcnt(4)
  v_mfma_f32_32x32x16_bf16 v[96:111], v[132:135], v[136:139], v[96:111]
  ds_read_b64_tr_b16 v[148:149], v55 offset:12288
  ds_read_b64_tr_b16 v[150:151], v55 offset:13312
  buffer_load_dwordx4 v25, s[12:15], s55 offen offset:1024 lds
  v_mfma_f32_32x32x16_bf16 v[112:127], v[132:135], v[140:143], v[112:127]
  buffer_load_dwordx4 v26, s[12:15], s55 offen offset:2048 lds
  buffer_load_dwordx4 v27, s[12:15], s55 offen offset:3072 lds
  s_waitcnt lgkmcnt(0)
  s_waitcnt vmcnt(8)
  s_barrier
  v_mfma_f32_32x32x16_bf16 v[64:79], v[144:147], v[152:155], v[64:79]
  ds_read_b64_tr_b16 v[128:129], v54 offset:32768
  ds_read_b64_tr_b16 v[130:131], v54 offset:33792
  v_mfma_f32_32x32x16_bf16 v[80:95], v[144:147], v[156:159], v[80:95]
  ds_read_b128 v[136:139], v46 offset:32768
  ds_read_b128 v[140:143], v46 offset:36864
  v_mfma_f32_32x32x16_bf16 v[96:111], v[148:151], v[152:155], v[96:111]
  ds_read_b64_tr_b16 v[132:133], v55 offset:32768
  ds_read_b64_tr_b16 v[134:135], v55 offset:33792
  v_mfma_f32_32x32x16_bf16 v[112:127], v[148:151], v[156:159], v[112:127]
  s_waitcnt lgkmcnt(3)
  v_mfma_f32_32x32x16_bf16 v[64:79], v[128:131], v[136:139], v[64:79]
  ds_read_b64_tr_b16 v[144:145], v54 offset:36864
  ds_read_b64_tr_b16 v[146:147], v54 offset:37888
  s_waitcnt lgkmcnt(4)
  v_mfma_f32_32x32x16_bf16 v[80:95], v[128:131], v[140:143], v[80:95]
  ds_read_b128 v[152:155], v47 offset:32768
  ds_read_b128 v[156:159], v47 offset:36864
  s_add_u32 m0, s50, 0
  s_add_u32 s55, s51, 768
  buffer_load_dwordx4 v20, s[8:11], s55 offen offset:0 lds
  s_waitcnt lgkmcnt(4)
  v_mfma_f32_32x32x16_bf16 v[96:111], v[132:135], v[136:139], v[96:111]
  ds_read_b64_tr_b16 v[148:149], v55 offset:36864
  ds_read_b64_tr_b16 v[150:151], v55 offset:37888
  buffer_load_dwordx4 v21, s[8:11], s55 offen offset:1024 lds
  v_mfma_f32_32x32x16_bf16 v[112:127], v[132:135], v[140:143], v[112:127]
  s_waitcnt lgkmcnt(3)
  v_mfma_f32_32x32x16_bf16 v[64:79], v[144:147], v[152:155], v[64:79]
  ds_read_b64_tr_b16 v[128:129], v54 offset:40960
  ds_read_b64_tr_b16 v[130:131], v54 offset:41984
  s_waitcnt lgkmcnt(4)
  v_mfma_f32_32x32x16_bf16 v[80:95], v[144:147], v[156:159], v[80:95]
  ds_read_b128 v[136:139], v48 offset:32768
  ds_read_b128 v[140:143], v48 offset:36864
  buffer_load_dwordx4 v22, s[8:11], s55 offen offset:2048 lds
  s_waitcnt lgkmcnt(4)
  v_mfma_f32_32x32x16_bf16 v[96:111], v[148:151], v[152:155], v[96:111]
  ds_read_b64_tr_b16 v[132:133], v55 offset:40960
  ds_read_b64_tr_b16 v[134:135], v55 offset:41984
  buffer_load_dwordx4 v23, s[8:11], s55 offen offset:3072 lds
  v_mfma_f32_32x32x16_bf16 v[112:127], v[148:151], v[156:159], v[112:127]
  s_waitcnt lgkmcnt(3)
  v_mfma_f32_32x32x16_bf16 v[64:79], v[128:131], v[136:139], v[64:79]
  ds_read_b64_tr_b16 v[144:145], v54 offset:45056
  ds_read_b64_tr_b16 v[146:147], v54 offset:46080
  s_waitcnt lgkmcnt(4)
  v_mfma_f32_32x32x16_bf16 v[80:95], v[128:131], v[140:143], v[80:95]
  ds_read_b128 v[152:155], v49 offset:32768
  ds_read_b128 v[156:159], v49 offset:36864
  s_add_u32 m0, s50, 16384
  s_add_u32 s55, s52, 1376256
  buffer_load_dwordx4 v24, s[12:15], s55 offen offset:0 lds
  s_waitcnt lgkmcnt(4)
  v_mfma_f32_32x32x16_bf16 v[96:111], v[132:135], v[136:139], v[96:111]
  ds_read_b64_tr_b16 v[148:149], v55 offset:45056
  ds_read_b64_tr_b16 v[150:151], v55 offset:46080
  buffer_load_dwordx4 v25, s[12:15], s55 offen offset:1024 lds
  v_mfma_f32_32x32x16_bf16 v[112:127], v[132:135], v[140:143], v[112:127]
  buffer_load_dwordx4 v26, s[12:15], s55 offen offset:2048 lds
  buffer_load_dwordx4 v27, s[12:15], s55 offen offset:3072 lds
  s_waitcnt lgkmcnt(0)
  s_waitcnt vmcnt(8)
  s_barrier
  v_mfma_f32_32x32x16_bf16 v[64:79], v[144:147], v[152:155], v[64:79]
  ds_read_b64_tr_b16 v[128:129], v56 offset:0
  ds_read_b64_tr_b16 v[130:131], v56 offset:1024
  v_mfma_f32_32x32x16_bf16 v[80:95], v[144:147], v[156:159], v[80:95]
  ds_read_b128 v[136:139], v50 offset:0
  ds_read_b128 v[140:143], v50 offset:4096
  s_and_b32 s59, s44, 1
  s_lshl_b32 s59, s59, 7
  s_lshl_b32 s56, s49, 8
  s_add_u32 s59, s59, s56
  v_and_b32 v8, 31, v1
  v_lshlrev_b32 v8, 1, v8
  v_add_u32 v8, s59, v8
  global_load_ushort v38, v8, s[82:83]
  global_load_ushort v42, v8, s[82:83] offset:64
  v_mfma_f32_32x32x16_bf16 v[96:111], v[148:151], v[152:155], v[96:111]
  ds_read_b64_tr_b16 v[132:133], v57 offset:0
  ds_read_b64_tr_b16 v[134:135], v57 offset:1024
  v_mov_b32 v8, 0xb12000
  global_load_dword v18, v8, s[20:21] sc1
  v_mfma_f32_32x32x16_bf16 v[112:127], v[148:151], v[156:159], v[112:127]
  s_waitcnt lgkmcnt(3)
  v_mfma_f32_32x32x16_bf16 v[64:79], v[128:131], v[136:139], v[64:79]
  ds_read_b64_tr_b16 v[144:145], v56 offset:4096
  ds_read_b64_tr_b16 v[146:147], v56 offset:5120
  s_waitcnt lgkmcnt(4)
  v_mfma_f32_32x32x16_bf16 v[80:95], v[128:131], v[140:143], v[80:95]
  ds_read_b128 v[152:155], v51 offset:0
  ds_read_b128 v[156:159], v51 offset:4096
  s_add_u32 m0, s50, 32768
  s_add_u32 s55, s51, 896
  buffer_load_dwordx4 v20, s[8:11], s55 offen offset:0 lds
  s_waitcnt lgkmcnt(4)
  v_mfma_f32_32x32x16_bf16 v[96:111], v[132:135], v[136:139], v[96:111]
  ds_read_b64_tr_b16 v[148:149], v57 offset:4096
  ds_read_b64_tr_b16 v[150:151], v57 offset:5120
  buffer_load_dwordx4 v21, s[8:11], s55 offen offset:1024 lds
  v_mfma_f32_32x32x16_bf16 v[112:127], v[132:135], v[140:143], v[112:127]
  s_waitcnt lgkmcnt(3)
  v_mfma_f32_32x32x16_bf16 v[64:79], v[144:147], v[152:155], v[64:79]
  ds_read_b64_tr_b16 v[128:129], v56 offset:8192
  ds_read_b64_tr_b16 v[130:131], v56 offset:9216
  s_waitcnt lgkmcnt(4)
  v_mfma_f32_32x32x16_bf16 v[80:95], v[144:147], v[156:159], v[80:95]
  ds_read_b128 v[136:139], v52 offset:0
  ds_read_b128 v[140:143], v52 offset:4096
  buffer_load_dwordx4 v22, s[8:11], s55 offen offset:2048 lds
  s_waitcnt lgkmcnt(4)
  v_mfma_f32_32x32x16_bf16 v[96:111], v[148:151], v[152:155], v[96:111]
  ds_read_b64_tr_b16 v[132:133], v57 offset:8192
  ds_read_b64_tr_b16 v[134:135], v57 offset:9216
  buffer_load_dwordx4 v23, s[8:11], s55 offen offset:3072 lds
  v_mfma_f32_32x32x16_bf16 v[112:127], v[148:151], v[156:159], v[112:127]
  s_waitcnt lgkmcnt(3)
  v_mfma_f32_32x32x16_bf16 v[64:79], v[128:131], v[136:139], v[64:79]
  ds_read_b64_tr_b16 v[144:145], v56 offset:12288
  ds_read_b64_tr_b16 v[146:147], v56 offset:13312
  s_waitcnt lgkmcnt(4)
  v_mfma_f32_32x32x16_bf16 v[80:95], v[128:131], v[140:143], v[80:95]
  ds_read_b128 v[152:155], v53 offset:0
  ds_read_b128 v[156:159], v53 offset:4096
  s_add_u32 m0, s50, 49152
  s_add_u32 s55, s52, 1605632
  buffer_load_dwordx4 v24, s[12:15], s55 offen offset:0 lds
  s_waitcnt lgkmcnt(4)
  v_mfma_f32_32x32x16_bf16 v[96:111], v[132:135], v[136:139], v[96:111]
  ds_read_b64_tr_b16 v[148:149], v57 offset:12288
  ds_read_b64_tr_b16 v[150:151], v57 offset:13312
  buffer_load_dwordx4 v25, s[12:15], s55 offen offset:1024 lds
  v_mfma_f32_32x32x16_bf16 v[112:127], v[132:135], v[140:143], v[112:127]
  buffer_load_dwordx4 v26, s[12:15], s55 offen offset:2048 lds
  buffer_load_dwordx4 v27, s[12:15], s55 offen offset:3072 lds
  s_waitcnt lgkmcnt(0)
  s_waitcnt vmcnt(11)
  s_barrier
  v_mfma_f32_32x32x16_bf16 v[64:79], v[144:147], v[152:155], v[64:79]
  ds_read_b64_tr_b16 v[128:129], v54 offset:0
  ds_read_b64_tr_b16 v[130:131], v54 offset:1024
  v_mfma_f32_32x32x16_bf16 v[80:95], v[144:147], v[156:159], v[80:95]
  ds_read_b128 v[136:139], v46 offset:0
  ds_read_b128 v[140:143], v46 offset:4096
  v_mfma_f32_32x32x16_bf16 v[96:111], v[148:151], v[152:155], v[96:111]
  ds_read_b64_tr_b16 v[132:133], v55 offset:0
  ds_read_b64_tr_b16 v[134:135], v55 offset:1024
  v_mfma_f32_32x32x16_bf16 v[112:127], v[148:151], v[156:159], v[112:127]
  v_and_b32 v2, 15, v1
  v_lshrrev_b32 v3, 4, v1
  v_and_b32 v4, 14, v2
  v_lshlrev_b32 v5, 3, v3
  v_sub_u32 v5, v5, v4
  v_lshlrev_b32 v5, 1, v5
  v_and_b32 v4, 1, v2
  v_xor_b32 v4, 1, v4
  v_mul_u32_u24 v4, 4160, v4
  s_waitcnt lgkmcnt(3)
  v_mfma_f32_32x32x16_bf16 v[64:79], v[128:131], v[136:139], v[64:79]
  ds_read_b64_tr_b16 v[144:145], v54 offset:4096
  ds_read_b64_tr_b16 v[146:147], v54 offset:5120
  s_waitcnt lgkmcnt(4)
  v_mfma_f32_32x32x16_bf16 v[80:95], v[128:131], v[140:143], v[80:95]
  ds_read_b128 v[152:155], v47 offset:0
  ds_read_b128 v[156:159], v47 offset:4096
  s_add_u32 m0, s93, 65536
  s_add_u32 s59, s92, 0
  buffer_load_dwordx4 v28, s[16:19], s59 offen lds
  s_waitcnt lgkmcnt(4)
  v_mfma_f32_32x32x16_bf16 v[96:111], v[132:135], v[136:139], v[96:111]
  ds_read_b64_tr_b16 v[148:149], v55 offset:4096
  ds_read_b64_tr_b16 v[150:151], v55 offset:5120
  v_mfma_f32_32x32x16_bf16 v[112:127], v[132:135], v[140:143], v[112:127]
  buffer_load_dwordx4 v29, s[16:19], s59 offen offset:1024 lds
  v_add_u32 v5, v5, v4
  s_mul_i32 s53, s57, 8320
  s_lshl_b32 s54, s58, 8
  s_sub_u32 s53, s53, s54
  s_add_u32 s53, s53, 101852
  v_add_u32 v20, s53, v5
  s_sub_u32 s53, s53, 1024
  v_add_u32 v21, s53, v5
  s_sub_u32 s53, s53, 1024
  s_waitcnt lgkmcnt(3)
  v_mfma_f32_32x32x16_bf16 v[64:79], v[144:147], v[152:155], v[64:79]
  ds_read_b64_tr_b16 v[128:129], v54 offset:8192
  ds_read_b64_tr_b16 v[130:131], v54 offset:9216
  s_waitcnt lgkmcnt(4)
  v_mfma_f32_32x32x16_bf16 v[80:95], v[144:147], v[156:159], v[80:95]
  ds_read_b128 v[136:139], v48 offset:0
  ds_read_b128 v[140:143], v48 offset:4096
  s_add_u32 m0, s93, 67584
  s_add_u32 s59, s92, 16384
  buffer_load_dwordx4 v28, s[16:19], s59 offen lds
  s_waitcnt lgkmcnt(4)
  v_mfma_f32_32x32x16_bf16 v[96:111], v[148:151], v[152:155], v[96:111]
  ds_read_b64_tr_b16 v[132:133], v55 offset:8192
  ds_read_b64_tr_b16 v[134:135], v55 offset:9216
  v_mfma_f32_32x32x16_bf16 v[112:127], v[148:151], v[156:159], v[112:127]
  buffer_load_dwordx4 v29, s[16:19], s59 offen offset:1024 lds
  v_add_u32 v22, s53, v5
  s_sub_u32 s53, s53, 1024
  v_add_u32 v23, s53, v5
  v_lshlrev_b32 v4, 5, v2
  v_lshl_add_u32 v4, v3, 4, v4
  s_mul_i32 s53, s57, 4608
  s_lshl_b32 s54, s58, 8
  s_sub_u32 s53, s53, s54
  s_add_u32 s53, s53, 115200
  s_waitcnt lgkmcnt(3)
  v_mfma_f32_32x32x16_bf16 v[64:79], v[128:131], v[136:139], v[64:79]
  ds_read_b64_tr_b16 v[144:145], v54 offset:12288
  ds_read_b64_tr_b16 v[146:147], v54 offset:13312
  s_waitcnt lgkmcnt(4)
  v_mfma_f32_32x32x16_bf16 v[80:95], v[128:131], v[140:143], v[80:95]
  ds_read_b128 v[152:155], v49 offset:0
  ds_read_b128 v[156:159], v49 offset:4096
  s_add_u32 m0, s93, 69632
  s_add_u32 s59, s92, 32768
  buffer_load_dwordx4 v28, s[16:19], s59 offen lds
  s_waitcnt lgkmcnt(4)
  v_mfma_f32_32x32x16_bf16 v[96:111], v[132:135], v[136:139], v[96:111]
  ds_read_b64_tr_b16 v[148:149], v55 offset:12288
  ds_read_b64_tr_b16 v[150:151], v55 offset:13312
  v_mfma_f32_32x32x16_bf16 v[112:127], v[132:135], v[140:143], v[112:127]
  buffer_load_dwordx4 v29, s[16:19], s59 offen offset:1024 lds
  v_add_u32 v24, s53, v4
  v_and_b32 v2, 15, v1
  v_lshrrev_b32 v3, 4, v1
  v_lshl_add_u32 v4, v2, 2, v3
  v_lshrrev_b32 v5, 3, v4
  v_and_b32 v5, 3, v5
  v_xor_b32 v4, v4, v5
  v_lshlrev_b32 v4, 4, v4
  s_lshl_b32 s53, s44, 13
  s_waitcnt lgkmcnt(0)
  s_waitcnt vmcnt(6)
  s_barrier
  v_mfma_f32_32x32x16_bf16 v[64:79], v[144:147], v[152:155], v[64:79]
  ds_read_b64_tr_b16 v[128:129], v54 offset:32768
  ds_read_b64_tr_b16 v[130:131], v54 offset:33792
  v_mfma_f32_32x32x16_bf16 v[80:95], v[144:147], v[156:159], v[80:95]
  ds_read_b128 v[136:139], v46 offset:32768
  ds_read_b128 v[140:143], v46 offset:36864
  s_add_u32 m0, s93, 71680
  s_add_u32 s59, s92, 49152
  buffer_load_dwordx4 v28, s[16:19], s59 offen lds
  v_mfma_f32_32x32x16_bf16 v[96:111], v[148:151], v[152:155], v[96:111]
  ds_read_b64_tr_b16 v[132:133], v55 offset:32768
  ds_read_b64_tr_b16 v[134:135], v55 offset:33792
  v_mfma_f32_32x32x16_bf16 v[112:127], v[148:151], v[156:159], v[112:127]
  buffer_load_dwordx4 v29, s[16:19], s59 offen offset:1024 lds
  s_add_u32 s53, s53, 124160
  v_add_u32 v25, s53, v4
  v_lshlrev_b32 v4, 1, v1
  v_lshrrev_b32 v5, 3, v4
  v_and_b32 v5, 3, v5
  v_xor_b32 v2, v4, v5
  v_lshlrev_b32 v2, 4, v2
  v_xor_b32 v3, 16, v2
  s_lshl_b32 s53, s57, 14
  s_waitcnt lgkmcnt(3)
  v_mfma_f32_32x32x16_bf16 v[64:79], v[128:131], v[136:139], v[64:79]
  ds_read_b64_tr_b16 v[144:145], v54 offset:36864
  ds_read_b64_tr_b16 v[146:147], v54 offset:37888
  s_waitcnt lgkmcnt(4)
  v_mfma_f32_32x32x16_bf16 v[80:95], v[128:131], v[140:143], v[80:95]
  ds_read_b128 v[152:155], v47 offset:32768
  ds_read_b128 v[156:159], v47 offset:36864
  s_waitcnt lgkmcnt(4)
  v_mfma_f32_32x32x16_bf16 v[96:111], v[132:135], v[136:139], v[96:111]
  ds_read_b64_tr_b16 v[148:149], v55 offset:36864
  ds_read_b64_tr_b16 v[150:151], v55 offset:37888
  v_mfma_f32_32x32x16_bf16 v[112:127], v[132:135], v[140:143], v[112:127]
  s_add_u32 m0, s93, 0
  s_add_u32 s59, s92, 65536
  buffer_load_dwordx4 v28, s[16:19], s59 offen lds
  s_lshl_b32 s54, s58, 12
  s_add_u32 s53, s53, s54
  s_add_u32 s53, s53, 124160
  v_add_u32 v26, s53, v2
  v_add_u32 v27, s53, v3
  s_mul_i32 s53, s57, 4608
  s_lshl_b32 s54, s58, 11
  s_add_u32 s53, s53, s54
  s_add_u32 s53, s53, 115424
  s_waitcnt lgkmcnt(3)
  v_mfma_f32_32x32x16_bf16 v[64:79], v[144:147], v[152:155], v[64:79]
  ds_read_b64_tr_b16 v[128:129], v54 offset:40960
  ds_read_b64_tr_b16 v[130:131], v54 offset:41984
  s_waitcnt lgkmcnt(4)
  v_mfma_f32_32x32x16_bf16 v[80:95], v[144:147], v[156:159], v[80:95]
  ds_read_b128 v[136:139], v48 offset:32768
  ds_read_b128 v[140:143], v48 offset:36864
  buffer_load_dwordx4 v29, s[16:19], s59 offen offset:1024 lds
  s_waitcnt lgkmcnt(4)
  v_mfma_f32_32x32x16_bf16 v[96:111], v[148:151], v[152:155], v[96:111]
  ds_read_b64_tr_b16 v[132:133], v55 offset:40960
  ds_read_b64_tr_b16 v[134:135], v55 offset:41984
  v_mfma_f32_32x32x16_bf16 v[112:127], v[148:151], v[156:159], v[112:127]
  s_add_u32 m0, s93, 2048
  s_add_u32 s59, s92, 81920
  buffer_load_dwordx4 v28, s[16:19], s59 offen lds
  v_lshlrev_b32 v2, 4, v1
  v_add_u32 v58, s53, v2
  s_lshl_b32 s53, s3, 12
  s_lshl_b32 s54, s58, 11
  s_add_u32 s53, s53, s54
  s_add_u32 s53, s53, 0x200000
  v_add_u32 v59, s53, v2
  s_waitcnt lgkmcnt(3)
  v_mfma_f32_32x32x16_bf16 v[64:79], v[128:131], v[136:139], v[64:79]
  ds_read_b64_tr_b16 v[144:145], v54 offset:45056
  ds_read_b64_tr_b16 v[146:147], v54 offset:46080
  s_waitcnt lgkmcnt(4)
  v_mfma_f32_32x32x16_bf16 v[80:95], v[128:131], v[140:143], v[80:95]
  ds_read_b128 v[152:155], v49 offset:32768
  ds_read_b128 v[156:159], v49 offset:36864
  buffer_load_dwordx4 v29, s[16:19], s59 offen offset:1024 lds
  s_waitcnt lgkmcnt(4)
  v_mfma_f32_32x32x16_bf16 v[96:111], v[132:135], v[136:139], v[96:111]
  ds_read_b64_tr_b16 v[148:149], v55 offset:45056
  ds_read_b64_tr_b16 v[150:151], v55 offset:46080
  v_mfma_f32_32x32x16_bf16 v[112:127], v[132:135], v[140:143], v[112:127]
  s_add_u32 m0, s93, 4096
  s_add_u32 s59, s92, 98304
  buffer_load_dwordx4 v28, s[16:19], s59 offen lds
  s_waitcnt lgkmcnt(3)
  v_mfma_f32_32x32x16_bf16 v[64:79], v[144:147], v[152:155], v[64:79]
  s_waitcnt lgkmcnt(2)
  v_mfma_f32_32x32x16_bf16 v[80:95], v[144:147], v[156:159], v[80:95]
  buffer_load_dwordx4 v29, s[16:19], s59 offen offset:1024 lds
  s_waitcnt lgkmcnt(0)
  v_mfma_f32_32x32x16_bf16 v[96:111], v[148:151], v[152:155], v[96:111]
  v_mfma_f32_32x32x16_bf16 v[112:127], v[148:151], v[156:159], v[112:127]
  s_barrier
  v_cmp_gt_u32 vcc, 32, v1
  s_nop 1
  v_cndmask_b32 v38, 0, v38, vcc
  v_cndmask_b32 v42, 0, v42, vcc
  s_nop 0
  v_mfma_f32_32x32x16_bf16 v[64:79], v[38:41], v[34:37], v[64:79]
  v_mfma_f32_32x32x16_bf16 v[80:95], v[38:41], v[34:37], v[80:95]
  v_mfma_f32_32x32x16_bf16 v[96:111], v[42:45], v[34:37], v[96:111]
  v_mfma_f32_32x32x16_bf16 v[112:127], v[42:45], v[34:37], v[112:127]
  s_lshl_b32 s53, s48, 2
  s_lshr_b32 s54, s44, 1
  s_lshl_b32 s54, s54, 1
  s_add_u32 s53, s53, s54
  s_mul_i32 s53, s53, 112
  s_lshl_b32 s54, s49, 3
  s_add_u32 s53, s53, s54
  s_and_b32 s54, s44, 1
  s_lshl_b32 s54, s54, 2
  s_add_u32 s53, s53, s54
  s_lshl_b32 s53, s53, 10
  s_add_u32 s53, s53, 0x400000
  v_lshlrev_b32 v2, 4, v1
  v_add_u32 v46, s53, v2
  v_add_u32 v47, 114688, v46
  s_lshl_b32 s53, s48, 7
  s_lshl_b32 s54, s49, 2
  s_add_u32 s53, s53, s54
  s_add_u32 s63, s53, 0xb10400
  v_readfirstlane_b32 s47, v18
  s_nop 1
  s_mul_i32 s47, s47, 0x9E3779B1
  s_add_u32 s47, s47, 0x7F4A7C15
  s_or_b32 s47, s47, 1
  v_min_u32 v61, 31, v1
  v_lshlrev_b32 v61, 2, v61
  v_add_u32 v61, 0xb10000, v61
  global_load_dword v60, v61, s[20:21] sc1
  v_pk_mul_f32 v[128:129], v[64:65], s[60:61]
  v_pk_mul_f32 v[130:131], v[66:67], s[60:61]
  v_pk_mul_f32 v[132:133], v[68:69], s[60:61]
  v_pk_mul_f32 v[134:135], v[70:71], s[60:61]
  v_exp_f32 v128, v128
  v_exp_f32 v129, v129
  v_exp_f32 v130, v130
  v_exp_f32 v131, v131
  v_exp_f32 v132, v132
  v_exp_f32 v133, v133
  v_exp_f32 v134, v134
  v_exp_f32 v135, v135
  s_add_u32 m0, s93, 6144
  s_add_u32 s59, s92, 114688
  buffer_load_dwordx4 v28, s[16:19], s59 offen lds
  v_pk_add_f32 v[128:129], v[128:129], 1.0 op_sel_hi:[1,0]
  v_pk_add_f32 v[130:131], v[130:131], 1.0 op_sel_hi:[1,0]
  v_pk_add_f32 v[132:133], v[132:133], 1.0 op_sel_hi:[1,0]
  v_pk_add_f32 v[134:135], v[134:135], 1.0 op_sel_hi:[1,0]
  v_pk_fma_f32 v[128:129], v[128:129], v[128:129], 1.0 op_sel_hi:[1,1,0]
  v_pk_fma_f32 v[130:131], v[130:131], v[130:131], 1.0 op_sel_hi:[1,1,0]
  v_pk_fma_f32 v[132:133], v[132:133], v[132:133], 1.0 op_sel_hi:[1,1,0]
  v_pk_fma_f32 v[134:135], v[134:135], v[134:135], 1.0 op_sel_hi:[1,1,0]
  v_rcp_f32 v128, v128
  v_rcp_f32 v129, v129
  v_rcp_f32 v130, v130
  v_rcp_f32 v131, v131
  v_rcp_f32 v132, v132
  v_rcp_f32 v133, v133
  v_rcp_f32 v134, v134
  v_rcp_f32 v135, v135
  buffer_load_dwordx4 v29, s[16:19], s59 offen offset:1024 lds
  v_pk_fma_f32 v[128:129], v[128:129], -2.0, 1.0 op_sel_hi:[1,0,0]
  v_pk_fma_f32 v[130:131], v[130:131], -2.0, 1.0 op_sel_hi:[1,0,0]
  v_pk_fma_f32 v[132:133], v[132:133], -2.0, 1.0 op_sel_hi:[1,0,0]
  v_pk_fma_f32 v[134:135], v[134:135], -2.0, 1.0 op_sel_hi:[1,0,0]
  v_pk_mul_f32 v[128:129], v[64:65], v[128:129]
  v_pk_mul_f32 v[130:131], v[66:67], v[130:131]
  v_pk_mul_f32 v[132:133], v[68:69], v[132:133]
  v_pk_mul_f32 v[134:135], v[70:71], v[134:135]
  v_cvt_pk_bf16_f32 v136, v128, v129
  v_cvt_pk_bf16_f32 v137, v130, v131
  v_cvt_pk_bf16_f32 v138, v132, v133
  v_cvt_pk_bf16_f32 v139, v134, v135
  global_store_dwordx4 v46, v[136:139], s[20:21] offset:0 sc1
  v_pk_mul_f32 v[144:145], v[80:81], s[60:61]
  v_pk_mul_f32 v[146:147], v[82:83], s[60:61]
  v_pk_mul_f32 v[148:149], v[84:85], s[60:61]
  v_pk_mul_f32 v[150:151], v[86:87], s[60:61]
  v_exp_f32 v144, v144
  v_exp_f32 v145, v145
  v_exp_f32 v146, v146
  v_exp_f32 v147, v147
  v_exp_f32 v148, v148
  v_exp_f32 v149, v149
  v_exp_f32 v150, v150
  v_exp_f32 v151, v151
  v_pk_add_f32 v[144:145], v[144:145], 1.0 op_sel_hi:[1,0]
  v_pk_add_f32 v[146:147], v[146:147], 1.0 op_sel_hi:[1,0]
  v_pk_add_f32 v[148:149], v[148:149], 1.0 op_sel_hi:[1,0]
  v_pk_add_f32 v[150:151], v[150:151], 1.0 op_sel_hi:[1,0]
  v_pk_fma_f32 v[144:145], v[144:145], v[144:145], 1.0 op_sel_hi:[1,1,0]
  v_pk_fma_f32 v[146:147], v[146:147], v[146:147], 1.0 op_sel_hi:[1,1,0]
  v_pk_fma_f32 v[148:149], v[148:149], v[148:149], 1.0 op_sel_hi:[1,1,0]
  v_pk_fma_f32 v[150:151], v[150:151], v[150:151], 1.0 op_sel_hi:[1,1,0]
  v_rcp_f32 v144, v144
  v_rcp_f32 v145, v145
  v_rcp_f32 v146, v146
  v_rcp_f32 v147, v147
  v_rcp_f32 v148, v148
  v_rcp_f32 v149, v149
  v_rcp_f32 v150, v150
  v_rcp_f32 v151, v151
  s_add_u32 m0, s93, 32768
  s_add_u32 s59, s92, 131072
  buffer_load_dwordx4 v28, s[16:19], s59 offen lds
  v_pk_fma_f32 v[144:145], v[144:145], -2.0, 1.0 op_sel_hi:[1,0,0]
  v_pk_fma_f32 v[146:147], v[146:147], -2.0, 1.0 op_sel_hi:[1,0,0]
  v_pk_fma_f32 v[148:149], v[148:149], -2.0, 1.0 op_sel_hi:[1,0,0]
  v_pk_fma_f32 v[150:151], v[150:151], -2.0, 1.0 op_sel_hi:[1,0,0]
  v_pk_mul_f32 v[144:145], v[80:81], v[144:145]
  v_pk_mul_f32 v[146:147], v[82:83], v[146:147]
  v_pk_mul_f32 v[148:149], v[84:85], v[148:149]
  v_pk_mul_f32 v[150:151], v[86:87], v[150:151]
  v_cvt_pk_bf16_f32 v152, v144, v145
  v_cvt_pk_bf16_f32 v153, v146, v147
  v_cvt_pk_bf16_f32 v154, v148, v149
  v_cvt_pk_bf16_f32 v155, v150, v151
  global_store_dwordx4 v47, v[152:155], s[20:21] offset:0 sc1
  v_pk_mul_f32 v[128:129], v[72:73], s[60:61]
  v_pk_mul_f32 v[130:131], v[74:75], s[60:61]
  v_pk_mul_f32 v[132:133], v[76:77], s[60:61]
  v_pk_mul_f32 v[134:135], v[78:79], s[60:61]
  v_exp_f32 v128, v128
  v_exp_f32 v129, v129
  v_exp_f32 v130, v130
  v_exp_f32 v131, v131
  v_exp_f32 v132, v132
  v_exp_f32 v133, v133
  v_exp_f32 v134, v134
  v_exp_f32 v135, v135
  v_pk_add_f32 v[128:129], v[128:129], 1.0 op_sel_hi:[1,0]
  v_pk_add_f32 v[130:131], v[130:131], 1.0 op_sel_hi:[1,0]
  v_pk_add_f32 v[132:133], v[132:133], 1.0 op_sel_hi:[1,0]
  v_pk_add_f32 v[134:135], v[134:135], 1.0 op_sel_hi:[1,0]
  v_pk_fma_f32 v[128:129], v[128:129], v[128:129], 1.0 op_sel_hi:[1,1,0]
  v_pk_fma_f32 v[130:131], v[130:131], v[130:131], 1.0 op_sel_hi:[1,1,0]
  v_pk_fma_f32 v[132:133], v[132:133], v[132:133], 1.0 op_sel_hi:[1,1,0]
  v_pk_fma_f32 v[134:135], v[134:135], v[134:135], 1.0 op_sel_hi:[1,1,0]
  v_rcp_f32 v128, v128
  v_rcp_f32 v129, v129
  v_rcp_f32 v130, v130
  v_rcp_f32 v131, v131
  v_rcp_f32 v132, v132
  v_rcp_f32 v133, v133
  v_rcp_f32 v134, v134
  v_rcp_f32 v135, v135
  v_pk_fma_f32 v[128:129], v[128:129], -2.0, 1.0 op_sel_hi:[1,0,0]
  v_pk_fma_f32 v[130:131], v[130:131], -2.0, 1.0 op_sel_hi:[1,0,0]
  v_pk_fma_f32 v[132:133], v[132:133], -2.0, 1.0 op_sel_hi:[1,0,0]
  v_pk_fma_f32 v[134:135], v[134:135], -2.0, 1.0 op_sel_hi:[1,0,0]
  v_pk_mul_f32 v[128:129], v[72:73], v[128:129]
  v_pk_mul_f32 v[130:131], v[74:75], v[130:131]
  v_pk_mul_f32 v[132:133], v[76:77], v[132:133]
  v_pk_mul_f32 v[134:135], v[78:79], v[134:135]
  v_cvt_pk_bf16_f32 v136, v128, v129
  v_cvt_pk_bf16_f32 v137, v130, v131
  v_cvt_pk_bf16_f32 v138, v132, v133
  v_cvt_pk_bf16_f32 v139, v134, v135
  global_store_dwordx4 v46, v[136:139], s[20:21] offset:1024 sc1
  v_pk_mul_f32 v[144:145], v[88:89], s[60:61]
  v_pk_mul_f32 v[146:147], v[90:91], s[60:61]
  v_pk_mul_f32 v[148:149], v[92:93], s[60:61]
  v_pk_mul_f32 v[150:151], v[94:95], s[60:61]
  v_exp_f32 v144, v144
  v_exp_f32 v145, v145
  v_exp_f32 v146, v146
  v_exp_f32 v147, v147
  v_exp_f32 v148, v148
  v_exp_f32 v149, v149
  v_exp_f32 v150, v150
  v_exp_f32 v151, v151
  v_pk_add_f32 v[144:145], v[144:145], 1.0 op_sel_hi:[1,0]
  v_pk_add_f32 v[146:147], v[146:147], 1.0 op_sel_hi:[1,0]
  v_pk_add_f32 v[148:149], v[148:149], 1.0 op_sel_hi:[1,0]
  v_pk_add_f32 v[150:151], v[150:151], 1.0 op_sel_hi:[1,0]
  v_pk_fma_f32 v[144:145], v[144:145], v[144:145], 1.0 op_sel_hi:[1,1,0]
  v_pk_fma_f32 v[146:147], v[146:147], v[146:147], 1.0 op_sel_hi:[1,1,0]
  v_pk_fma_f32 v[148:149], v[148:149], v[148:149], 1.0 op_sel_hi:[1,1,0]
  v_pk_fma_f32 v[150:151], v[150:151], v[150:151], 1.0 op_sel_hi:[1,1,0]
  v_rcp_f32 v144, v144
  v_rcp_f32 v145, v145
  v_rcp_f32 v146, v146
  v_rcp_f32 v147, v147
  v_rcp_f32 v148, v148
  v_rcp_f32 v149, v149
  v_rcp_f32 v150, v150
  v_rcp_f32 v151, v151
  v_pk_fma_f32 v[144:145], v[144:145], -2.0, 1.0 op_sel_hi:[1,0,0]
  v_pk_fma_f32 v[146:147], v[146:147], -2.0, 1.0 op_sel_hi:[1,0,0]
  v_pk_fma_f32 v[148:149], v[148:149], -2.0, 1.0 op_sel_hi:[1,0,0]
  v_pk_fma_f32 v[150:151], v[150:151], -2.0, 1.0 op_sel_hi:[1,0,0]
  v_pk_mul_f32 v[144:145], v[88:89], v[144:145]
  v_pk_mul_f32 v[146:147], v[90:91], v[146:147]
  v_pk_mul_f32 v[148:149], v[92:93], v[148:149]
  v_pk_mul_f32 v[150:151], v[94:95], v[150:151]
  v_cvt_pk_bf16_f32 v152, v144, v145
  v_cvt_pk_bf16_f32 v153, v146, v147
  v_cvt_pk_bf16_f32 v154, v148, v149
  v_cvt_pk_bf16_f32 v155, v150, v151
  global_store_dwordx4 v47, v[152:155], s[20:21] offset:1024 sc1
  s_waitcnt vmcnt(7)
  v_cmp_ne_u32 vcc, s47, v60
  s_cbranch_vccnz Lslow_2
Lback_3:
  s_lshl_b32 s53, s45, 2
  s_lshr_b32 s54, s46, 3
  s_add_u32 s53, s53, s54
  s_lshl_b32 s53, s53, 16
  s_lshl_b32 s54, s46, 1
  s_and_b32 s54, s54, 15
  s_lshl_b32 s54, s54, 4
  s_add_u32 s53, s53, s54
  s_lshl_b32 s54, s44, 13
  s_add_u32 s53, s53, s54
  v_lshrrev_b32 v2, 1, v1
  v_and_b32 v3, 1, v1
  v_lshlrev_b32 v4, 8, v2
  v_lshl_add_u32 v4, v3, 4, v4
  v_add_u32 v4, s53, v4
  global_load_dwordx4 v[216:219], v4, s[20:21] sc1
  v_add_u32 v4, 32768, v4
  global_load_dwordx4 v[220:223], v4, s[20:21] sc1
  v_mul_u32_u24 v3, 4608, v3
  v_lshl_add_u32 v3, v2, 4, v3
  s_lshl_b32 s54, s44, 9
  s_add_u32 s54, s54, 115424
  v_add_u32 v19, s54, v3
  v_pk_mul_f32 v[128:129], v[96:97], s[60:61]
  v_pk_mul_f32 v[130:131], v[98:99], s[60:61]
  v_pk_mul_f32 v[132:133], v[100:101], s[60:61]
  v_pk_mul_f32 v[134:135], v[102:103], s[60:61]
  v_exp_f32 v128, v128
  v_exp_f32 v129, v129
  v_exp_f32 v130, v130
  v_exp_f32 v131, v131
  v_exp_f32 v132, v132
  v_exp_f32 v133, v133
  v_exp_f32 v134, v134
  v_exp_f32 v135, v135
  v_pk_add_f32 v[128:129], v[128:129], 1.0 op_sel_hi:[1,0]
  v_pk_add_f32 v[130:131], v[130:131], 1.0 op_sel_hi:[1,0]
  v_pk_add_f32 v[132:133], v[132:133], 1.0 op_sel_hi:[1,0]
  v_pk_add_f32 v[134:135], v[134:135], 1.0 op_sel_hi:[1,0]
  v_pk_fma_f32 v[128:129], v[128:129], v[128:129], 1.0 op_sel_hi:[1,1,0]
  v_pk_fma_f32 v[130:131], v[130:131], v[130:131], 1.0 op_sel_hi:[1,1,0]
  v_pk_fma_f32 v[132:133], v[132:133], v[132:133], 1.0 op_sel_hi:[1,1,0]
  v_pk_fma_f32 v[134:135], v[134:135], v[134:135], 1.0 op_sel_hi:[1,1,0]
  v_rcp_f32 v128, v128
  v_rcp_f32 v129, v129
  v_rcp_f32 v130, v130
  v_rcp_f32 v131, v131
  v_rcp_f32 v132, v132
  v_rcp_f32 v133, v133
  v_rcp_f32 v134, v134
  v_rcp_f32 v135, v135
  v_pk_fma_f32 v[128:129], v[128:129], -2.0, 1.0 op_sel_hi:[1,0,0]
  v_pk_fma_f32 v[130:131], v[130:131], -2.0, 1.0 op_sel_hi:[1,0,0]
  v_pk_fma_f32 v[132:133], v[132:133], -2.0, 1.0 op_sel_hi:[1,0,0]
  v_pk_fma_f32 v[134:135], v[134:135], -2.0, 1.0 op_sel_hi:[1,0,0]
  v_pk_mul_f32 v[128:129], v[96:97], v[128:129]
  v_pk_mul_f32 v[130:131], v[98:99], v[130:131]
  v_pk_mul_f32 v[132:133], v[100:101], v[132:133]
  v_pk_mul_f32 v[134:135], v[102:103], v[134:135]
  v_cvt_pk_bf16_f32 v136, v128, v129
  v_cvt_pk_bf16_f32 v137, v130, v131
  v_cvt_pk_bf16_f32 v138, v132, v133
  v_cvt_pk_bf16_f32 v139, v134, v135
  global_store_dwordx4 v46, v[136:139], s[20:21] offset:2048 sc1
  v_pk_mul_f32 v[144:145], v[112:113], s[60:61]
  v_pk_mul_f32 v[146:147], v[114:115], s[60:61]
  v_pk_mul_f32 v[148:149], v[116:117], s[60:61]
  v_pk_mul_f32 v[150:151], v[118:119], s[60:61]
  v_exp_f32 v144, v144
  v_exp_f32 v145, v145
  v_exp_f32 v146, v146
  v_exp_f32 v147, v147
  v_exp_f32 v148, v148
  v_exp_f32 v149, v149
  v_exp_f32 v150, v150
  v_exp_f32 v151, v151
  v_pk_add_f32 v[144:145], v[144:145], 1.0 op_sel_hi:[1,0]
  v_pk_add_f32 v[146:147], v[146:147], 1.0 op_sel_hi:[1,0]
  v_pk_add_f32 v[148:149], v[148:149], 1.0 op_sel_hi:[1,0]
  v_pk_add_f32 v[150:151], v[150:151], 1.0 op_sel_hi:[1,0]
  v_pk_fma_f32 v[144:145], v[144:145], v[144:145], 1.0 op_sel_hi:[1,1,0]
  v_pk_fma_f32 v[146:147], v[146:147], v[146:147], 1.0 op_sel_hi:[1,1,0]
  v_pk_fma_f32 v[148:149], v[148:149], v[148:149], 1.0 op_sel_hi:[1,1,0]
  v_pk_fma_f32 v[150:151], v[150:151], v[150:151], 1.0 op_sel_hi:[1,1,0]
  v_rcp_f32 v144, v144
  v_rcp_f32 v145, v145
  v_rcp_f32 v146, v146
  v_rcp_f32 v147, v147
  v_rcp_f32 v148, v148
  v_rcp_f32 v149, v149
  v_rcp_f32 v150, v150
  v_rcp_f32 v151, v151
  v_pk_fma_f32 v[144:145], v[144:145], -2.0, 1.0 op_sel_hi:[1,0,0]
  v_pk_fma_f32 v[146:147], v[146:147], -2.0, 1.0 op_sel_hi:[1,0,0]
  v_pk_fma_f32 v[148:149], v[148:149], -2.0, 1.0 op_sel_hi:[1,0,0]
  v_pk_fma_f32 v[150:151], v[150:151], -2.0, 1.0 op_sel_hi:[1,0,0]
  v_pk_mul_f32 v[144:145], v[112:113], v[144:145]
  v_pk_mul_f32 v[146:147], v[114:115], v[146:147]
  v_pk_mul_f32 v[148:149], v[116:117], v[148:149]
  v_pk_mul_f32 v[150:151], v[118:119], v[150:151]
  v_cvt_pk_bf16_f32 v152, v144, v145
  v_cvt_pk_bf16_f32 v153, v146, v147
  v_cvt_pk_bf16_f32 v154, v148, v149
  v_cvt_pk_bf16_f32 v155, v150, v151
  global_store_dwordx4 v47, v[152:155], s[20:21] offset:2048 sc1
  v_pk_mul_f32 v[128:129], v[104:105], s[60:61]
  v_pk_mul_f32 v[130:131], v[106:107], s[60:61]
  v_pk_mul_f32 v[132:133], v[108:109], s[60:61]
  v_pk_mul_f32 v[134:135], v[110:111], s[60:61]
  v_exp_f32 v128, v128
  v_exp_f32 v129, v129
  v_exp_f32 v130, v130
  v_exp_f32 v131, v131
  v_exp_f32 v132, v132
  v_exp_f32 v133, v133
  v_exp_f32 v134, v134
  v_exp_f32 v135, v135
  v_pk_add_f32 v[128:129], v[128:129], 1.0 op_sel_hi:[1,0]
  v_pk_add_f32 v[130:131], v[130:131], 1.0 op_sel_hi:[1,0]
  v_pk_add_f32 v[132:133], v[132:133], 1.0 op_sel_hi:[1,0]
  v_pk_add_f32 v[134:135], v[134:135], 1.0 op_sel_hi:[1,0]
  v_pk_fma_f32 v[128:129], v[128:129], v[128:129], 1.0 op_sel_hi:[1,1,0]
  v_pk_fma_f32 v[130:131], v[130:131], v[130:131], 1.0 op_sel_hi:[1,1,0]
  v_pk_fma_f32 v[132:133], v[132:133], v[132:133], 1.0 op_sel_hi:[1,1,0]
  v_pk_fma_f32 v[134:135], v[134:135], v[134:135], 1.0 op_sel_hi:[1,1,0]
  v_rcp_f32 v128, v128
  v_rcp_f32 v129, v129
  v_rcp_f32 v130, v130
  v_rcp_f32 v131, v131
  v_rcp_f32 v132, v132
  v_rcp_f32 v133, v133
  v_rcp_f32 v134, v134
  v_rcp_f32 v135, v135
  v_pk_fma_f32 v[128:129], v[128:129], -2.0, 1.0 op_sel_hi:[1,0,0]
  v_pk_fma_f32 v[130:131], v[130:131], -2.0, 1.0 op_sel_hi:[1,0,0]
  v_pk_fma_f32 v[132:133], v[132:133], -2.0, 1.0 op_sel_hi:[1,0,0]
  v_pk_fma_f32 v[134:135], v[134:135], -2.0, 1.0 op_sel_hi:[1,0,0]
  v_pk_mul_f32 v[128:129], v[104:105], v[128:129]
  v_pk_mul_f32 v[130:131], v[106:107], v[130:131]
  v_pk_mul_f32 v[132:133], v[108:109], v[132:133]
  v_pk_mul_f32 v[134:135], v[110:111], v[134:135]
  v_cvt_pk_bf16_f32 v136, v128, v129
  v_cvt_pk_bf16_f32 v137, v130, v131
  v_cvt_pk_bf16_f32 v138, v132, v133
  v_cvt_pk_bf16_f32 v139, v134, v135
  global_store_dwordx4 v46, v[136:139], s[20:21] offset:3072 sc1
  s_waitcnt vmcnt(4)
  ds_write_b128 v19, v[216:219]
  s_waitcnt vmcnt(3)
  ds_write_b128 v19, v[220:223] offset:2048
  v_mov_b32 v160, 0
  v_mov_b32 v161, 0
  v_mov_b32 v162, 0
  v_mov_b32 v163, 0
  s_mul_i32 s54, s57, 4608
  s_add_u32 s54, s54, 114944
  v_lshlrev_b32 v2, 4, v1
  v_add_u32 v2, s54, v2
  s_mov_b64 s[88:89], exec
  s_mov_b64 exec, 0x3fffffff
  ds_write_b128 v2, v[160:163]
  s_mov_b64 exec, s[88:89]
  v_pk_mul_f32 v[144:145], v[120:121], s[60:61]
  v_pk_mul_f32 v[146:147], v[122:123], s[60:61]
  v_pk_mul_f32 v[148:149], v[124:125], s[60:61]
  v_pk_mul_f32 v[150:151], v[126:127], s[60:61]
  v_exp_f32 v144, v144
  v_exp_f32 v145, v145
  v_exp_f32 v146, v146
  v_exp_f32 v147, v147
  v_exp_f32 v148, v148
  v_exp_f32 v149, v149
  v_exp_f32 v150, v150
  v_exp_f32 v151, v151
  v_pk_add_f32 v[144:145], v[144:145], 1.0 op_sel_hi:[1,0]
  v_pk_add_f32 v[146:147], v[146:147], 1.0 op_sel_hi:[1,0]
  v_pk_add_f32 v[148:149], v[148:149], 1.0 op_sel_hi:[1,0]
  v_pk_add_f32 v[150:151], v[150:151], 1.0 op_sel_hi:[1,0]
  v_pk_fma_f32 v[144:145], v[144:145], v[144:145], 1.0 op_sel_hi:[1,1,0]
  v_pk_fma_f32 v[146:147], v[146:147], v[146:147], 1.0 op_sel_hi:[1,1,0]
  v_pk_fma_f32 v[148:149], v[148:149], v[148:149], 1.0 op_sel_hi:[1,1,0]
  v_pk_fma_f32 v[150:151], v[150:151], v[150:151], 1.0 op_sel_hi:[1,1,0]
  v_rcp_f32 v144, v144
  v_rcp_f32 v145, v145
  v_rcp_f32 v146, v146
  v_rcp_f32 v147, v147
  v_rcp_f32 v148, v148
  v_rcp_f32 v149, v149
  v_rcp_f32 v150, v150
  v_rcp_f32 v151, v151
  v_pk_fma_f32 v[144:145], v[144:145], -2.0, 1.0 op_sel_hi:[1,0,0]
  v_pk_fma_f32 v[146:147], v[146:147], -2.0, 1.0 op_sel_hi:[1,0,0]
  v_pk_fma_f32 v[148:149], v[148:149], -2.0, 1.0 op_sel_hi:[1,0,0]
  v_pk_fma_f32 v[150:151], v[150:151], -2.0, 1.0 op_sel_hi:[1,0,0]
  v_pk_mul_f32 v[144:145], v[120:121], v[144:145]
  v_pk_mul_f32 v[146:147], v[122:123], v[146:147]
  v_pk_mul_f32 v[148:149], v[124:125], v[148:149]
  v_pk_mul_f32 v[150:151], v[126:127], v[150:151]
  v_cvt_pk_bf16_f32 v152, v144, v145
  v_cvt_pk_bf16_f32 v153, v146, v147
  v_cvt_pk_bf16_f32 v154, v148, v149
  v_cvt_pk_bf16_f32 v155, v150, v151
  global_store_dwordx4 v47, v[152:155], s[20:21] offset:3072 sc1
Lcommon:
  ds_read2_b32 v[128:129], v20 offset0:128 offset1:129
  ds_read2_b32 v[130:131], v20 offset0:130 offset1:131
  ds_read2_b32 v[132:133], v20 offset0:0 offset1:1
  ds_read2_b32 v[134:135], v20 offset0:2 offset1:3
  ds_read2_b32 v[136:137], v21 offset0:128 offset1:129
  ds_read2_b32 v[138:139], v21 offset0:130 offset1:131
  ds_read2_b32 v[140:141], v21 offset0:0 offset1:1
  ds_read2_b32 v[142:143], v21 offset0:2 offset1:3
  ds_read2_b32 v[144:145], v22 offset0:128 offset1:129
  ds_read2_b32 v[146:147], v22 offset0:130 offset1:131
  ds_read2_b32 v[148:149], v22 offset0:0 offset1:1
  ds_read2_b32 v[150:151], v22 offset0:2 offset1:3
  ds_read2_b32 v[152:153], v23 offset0:128 offset1:129
  ds_read2_b32 v[154:155], v23 offset0:130 offset1:131
  ds_read2_b32 v[156:157], v23 offset0:0 offset1:1
  ds_read2_b32 v[158:159], v23 offset0:2 offset1:3
  s_waitcnt lgkmcnt(0)
  s_barrier
  ds_read_b128 v[160:163], v24 offset:192
  ds_read_b128 v[164:167], v24 offset:704
  ds_read_b128 v[168:171], v24 offset:1216
  ds_read_b128 v[172:175], v24 offset:1728
  ds_read_b128 v[176:179], v24 offset:2240
  ds_read_b128 v[180:183], v24 offset:2752
  ds_read_b128 v[184:187], v24 offset:3264
  ds_read_b128 v[188:191], v24 offset:3776
  v_subrev_u32 v20, 64, v20
  v_subrev_u32 v21, 64, v21
  v_subrev_u32 v22, 64, v22
  v_subrev_u32 v23, 64, v23
  s_waitcnt lgkmcnt(7)
  v_mfma_f32_16x16x32_bf16 v[64:67], v[128:131], v[160:163], 0
  buffer_load_dwordx4 v29, s[16:19], s59 offen offset:1024 lds
  s_waitcnt lgkmcnt(6)
  v_mfma_f32_16x16x32_bf16 v[68:71], v[128:131], v[164:167], 0
  v_mfma_f32_16x16x32_bf16 v[68:71], v[132:135], v[160:163], v[68:71]
  v_mfma_f32_16x16x32_bf16 v[72:75], v[132:135], v[164:167], 0
  s_waitcnt lgkmcnt(5)
  v_mfma_f32_16x16x32_bf16 v[72:75], v[128:131], v[168:171], v[72:75]
  s_add_u32 m0, s93, 34816
  s_add_u32 s59, s92, 147456
  buffer_load_dwordx4 v28, s[16:19], s59 offen lds
  v_mfma_f32_16x16x32_bf16 v[72:75], v[136:139], v[160:163], v[72:75]
  v_mfma_f32_16x16x32_bf16 v[76:79], v[132:135], v[168:171], 0
  ds_read_b128 v[224:227], v24 offset:128
  v_mfma_f32_16x16x32_bf16 v[76:79], v[136:139], v[164:167], v[76:79]
  ds_read2_b32 v[192:193], v20 offset0:128 offset1:129
  v_mfma_f32_16x16x32_bf16 v[80:83], v[136:139], v[168:171], 0
  ds_read2_b32 v[194:195], v20 offset0:130 offset1:131
  s_waitcnt lgkmcnt(7)
  v_mfma_f32_16x16x32_bf16 v[76:79], v[128:131], v[172:175], v[76:79]
  ds_read_b128 v[228:231], v24 offset:640
  buffer_load_dwordx4 v29, s[16:19], s59 offen offset:1024 lds
  v_mfma_f32_16x16x32_bf16 v[76:79], v[140:143], v[160:163], v[76:79]
  ds_read2_b32 v[196:197], v20 offset0:0 offset1:1
  v_mfma_f32_16x16x32_bf16 v[80:83], v[132:135], v[172:175], v[80:83]
  ds_read2_b32 v[198:199], v20 offset0:2 offset1:3
  v_mfma_f32_16x16x32_bf16 v[80:83], v[140:143], v[164:167], v[80:83]
  ds_read_b128 v[232:235], v24 offset:1152
  s_add_u32 m0, s93, 36864
  s_add_u32 s59, s92, 163840
  buffer_load_dwordx4 v28, s[16:19], s59 offen lds
  v_mfma_f32_16x16x32_bf16 v[84:87], v[136:139], v[172:175], 0
  ds_read2_b32 v[200:201], v21 offset0:128 offset1:129
  v_mfma_f32_16x16x32_bf16 v[84:87], v[140:143], v[168:171], v[84:87]
  ds_read2_b32 v[202:203], v21 offset0:130 offset1:131
  v_mfma_f32_16x16x32_bf16 v[88:91], v[140:143], v[172:175], 0
  ds_read_b128 v[236:239], v24 offset:1664
  buffer_load_dwordx4 v29, s[16:19], s59 offen offset:1024 lds
  s_waitcnt lgkmcnt(13)
  v_mfma_f32_16x16x32_bf16 v[80:83], v[128:131], v[176:179], v[80:83]
  ds_read2_b32 v[204:205], v21 offset0:0 offset1:1
  v_mfma_f32_16x16x32_bf16 v[80:83], v[144:147], v[160:163], v[80:83]
  ds_read2_b32 v[206:207], v21 offset0:2 offset1:3
  v_mfma_f32_16x16x32_bf16 v[84:87], v[132:135], v[176:179], v[84:87]
  ds_read_b128 v[240:243], v24 offset:2176
  s_add_u32 m0, s93, 38912
  s_add_u32 s59, s92, 180224
  buffer_load_dwordx4 v28, s[16:19], s59 offen lds
  v_mfma_f32_16x16x32_bf16 v[84:87], v[144:147], v[164:167], v[84:87]
  ds_read2_b32 v[208:209], v22 offset0:128 offset1:129
  v_mfma_f32_16x16x32_bf16 v[88:91], v[136:139], v[176:179], v[88:91]
  ds_read2_b32 v[210:211], v22 offset0:130 offset1:131
  v_mfma_f32_16x16x32_bf16 v[88:91], v[144:147], v[168:171], v[88:91]
  ds_read_b128 v[244:247], v24 offset:2688
  buffer_load_dwordx4 v29, s[16:19], s59 offen offset:1024 lds
  v_mfma_f32_16x16x32_bf16 v[92:95], v[140:143], v[176:179], 0
  ds_read2_b32 v[212:213], v22 offset0:0 offset1:1
  v_mfma_f32_16x16x32_bf16 v[92:95], v[144:147], v[172:175], v[92:95]
  s_waitcnt vmcnt(7)
  s_barrier
  s_cmp_ge_u32 s46, 28
  s_cbranch_scc1 Lnoflag_4
  s_cmp_lg_u32 s44, 0
  s_cbranch_scc1 Lnoflag_4
  v_mov_b32 v62, s63
  v_mov_b32 v63, s47
  s_mov_b64 s[88:89], exec
  s_mov_b64 exec, 1
  global_store_dword v62, v63, s[20:21] sc1
  s_mov_b64 exec, s[88:89]
Lnoflag_4:
  ds_read2_b32 v[214:215], v22 offset0:2 offset1:3
  s_waitcnt lgkmcnt(15)
  v_mfma_f32_16x16x32_bf16 v[84:87], v[128:131], v[180:183], v[84:87]
  ds_read_b128 v[248:251], v24 offset:3200
  ds_read_b64_tr_b16 a[0:1], v30 offset:0
  ds_read_b64_tr_b16 a[2:3], v30 offset:1024
  ds_read_b64_tr_b16 a[4:5], v31 offset:0
  ds_read_b64_tr_b16 a[6:7], v31 offset:1024
  v_mfma_f32_16x16x32_bf16 v[84:87], v[148:151], v[160:163], v[84:87]
  ds_read2_b32 v[216:217], v23 offset0:128 offset1:129
  v_mfma_f32_16x16x32_bf16 v[88:91], v[132:135], v[180:183], v[88:91]
  ds_read2_b32 v[218:219], v23 offset0:130 offset1:131
  v_mfma_f32_16x16x32_bf16 v[88:91], v[148:151], v[164:167], v[88:91]
  ds_read_b128 v[252:255], v24 offset:3712
  s_waitcnt lgkmcnt(3)
  s_add_u32 m0, s93, 65536
  s_add_u32 s59, s92, 196608
  buffer_load_dwordx4 v28, s[16:19], s59 offen lds
  v_mfma_f32_16x16x32_bf16 v[92:95], v[136:139], v[180:183], v[92:95]
  ds_read2_b32 v[220:221], v23 offset0:0 offset1:1
  v_mfma_f32_16x16x32_bf16 v[92:95], v[148:151], v[168:171], v[92:95]
  ds_read2_b32 v[222:223], v23 offset0:2 offset1:3
  v_mfma_f32_16x16x32_bf16 v[88:91], v[128:131], v[184:187], v[88:91]
  v_mfma_f32_16x16x32_bf16 v[88:91], v[152:155], v[160:163], v[88:91]
  buffer_load_dwordx4 v29, s[16:19], s59 offen offset:1024 lds
  v_mfma_f32_16x16x32_bf16 v[92:95], v[132:135], v[184:187], v[92:95]
  v_mfma_f32_16x16x32_bf16 v[92:95], v[152:155], v[164:167], v[92:95]
  v_mfma_f32_16x16x32_bf16 v[92:95], v[128:131], v[188:191], v[92:95]
  v_mfma_f32_16x16x32_bf16 v[92:95], v[156:159], v[160:163], v[92:95]
  ds_read_b64_tr_b16 a[8:9], v30 offset:2048
  ds_read_b64_tr_b16 a[10:11], v30 offset:3072
  ds_read_b64_tr_b16 a[12:13], v31 offset:2048
  ds_read_b64_tr_b16 a[14:15], v31 offset:3072
  v_subrev_u32 v20, 64, v20
  v_subrev_u32 v21, 64, v21
  v_subrev_u32 v22, 64, v22
  v_subrev_u32 v23, 64, v23
  v_mfma_f32_16x16x32_bf16 v[64:67], v[192:195], v[224:227], v[64:67]
  v_mfma_f32_16x16x32_bf16 v[68:71], v[192:195], v[228:231], v[68:71]
  v_mfma_f32_16x16x32_bf16 v[72:75], v[192:195], v[232:235], v[72:75]
  s_waitcnt lgkmcnt(0)
  s_add_u32 m0, s93, 67584
  s_add_u32 s59, s92, 212992
  buffer_load_dwordx4 v28, s[16:19], s59 offen lds
  v_mfma_f32_16x16x32_bf16 v[76:79], v[192:195], v[236:239], v[76:79]
  v_mfma_f32_16x16x32_bf16 v[80:83], v[192:195], v[240:243], v[80:83]
  v_mfma_f32_16x16x32_bf16 v[84:87], v[192:195], v[244:247], v[84:87]
  v_mfma_f32_16x16x32_bf16 v[88:91], v[192:195], v[248:251], v[88:91]
  ds_read_b128 v[160:163], v24 offset:64
  buffer_load_dwordx4 v29, s[16:19], s59 offen offset:1024 lds
  v_mfma_f32_16x16x32_bf16 v[92:95], v[192:195], v[252:255], v[92:95]
  ds_read2_b32 v[128:129], v20 offset0:128 offset1:129
  v_mfma_f32_16x16x32_bf16 v[68:71], v[196:199], v[224:227], v[68:71]
  ds_read2_b32 v[130:131], v20 offset0:130 offset1:131
  v_mfma_f32_16x16x32_bf16 v[72:75], v[196:199], v[228:231], v[72:75]
  ds_read_b128 v[164:167], v24 offset:576
  ds_read_b64_tr_b16 a[16:17], v30 offset:4096
  ds_read_b64_tr_b16 a[18:19], v30 offset:5120
  ds_read_b64_tr_b16 a[20:21], v31 offset:4096
  ds_read_b64_tr_b16 a[22:23], v31 offset:5120
  v_mfma_f32_16x16x32_bf16 v[76:79], v[196:199], v[232:235], v[76:79]
  ds_read2_b32 v[132:133], v20 offset0:0 offset1:1
  v_mfma_f32_16x16x32_bf16 v[80:83], v[196:199], v[236:239], v[80:83]
  ds_read2_b32 v[134:135], v20 offset0:2 offset1:3
  v_mfma_f32_16x16x32_bf16 v[84:87], v[196:199], v[240:243], v[84:87]
  ds_read_b128 v[168:171], v24 offset:1088
  s_waitcnt lgkmcnt(3)
  s_add_u32 m0, s93, 69632
  s_add_u32 s59, s92, 229376
  buffer_load_dwordx4 v28, s[16:19], s59 offen lds
  v_mfma_f32_16x16x32_bf16 v[88:91], v[196:199], v[244:247], v[88:91]
  ds_read2_b32 v[136:137], v21 offset0:128 offset1:129
  v_mfma_f32_16x16x32_bf16 v[92:95], v[196:199], v[248:251], v[92:95]
  ds_read2_b32 v[138:139], v21 offset0:130 offset1:131
  v_mfma_f32_16x16x32_bf16 v[72:75], v[200:203], v[224:227], v[72:75]
  ds_read_b128 v[172:175], v24 offset:1600
  buffer_load_dwordx4 v29, s[16:19], s59 offen offset:1024 lds
  v_mfma_f32_16x16x32_bf16 v[76:79], v[200:203], v[228:231], v[76:79]
  ds_read2_b32 v[140:141], v21 offset0:0 offset1:1
  v_mfma_f32_16x16x32_bf16 v[80:83], v[200:203], v[232:235], v[80:83]
  ds_read2_b32 v[142:143], v21 offset0:2 offset1:3
  v_mfma_f32_16x16x32_bf16 v[84:87], v[200:203], v[236:239], v[84:87]
  ds_read_b128 v[176:179], v24 offset:2112
  ds_read_b64_tr_b16 a[24:25], v30 offset:6144
  ds_read_b64_tr_b16 a[26:27], v30 offset:7168
  ds_read_b64_tr_b16 a[28:29], v31 offset:6144
  ds_read_b64_tr_b16 a[30:31], v31 offset:7168
  v_mfma_f32_16x16x32_bf16 v[88:91], v[200:203], v[240:243], v[88:91]
  ds_read2_b32 v[144:145], v22 offset0:128 offset1:129
  v_mfma_f32_16x16x32_bf16 v[92:95], v[200:203], v[244:247], v[92:95]
  ds_read2_b32 v[146:147], v22 offset0:130 offset1:131
  v_mfma_f32_16x16x32_bf16 v[76:79], v[204:207], v[224:227], v[76:79]
  ds_read_b128 v[180:183], v24 offset:2624
  s_waitcnt lgkmcnt(3)
  s_add_u32 m0, s93, 71680
  s_add_u32 s59, s92, 245760
  buffer_load_dwordx4 v28, s[16:19], s59 offen lds
  v_mfma_f32_16x16x32_bf16 v[80:83], v[204:207], v[228:231], v[80:83]
  ds_read2_b32 v[148:149], v22 offset0:0 offset1:1
  v_mfma_f32_16x16x32_bf16 v[84:87], v[204:207], v[232:235], v[84:87]
  ds_read2_b32 v[150:151], v22 offset0:2 offset1:3
  v_mfma_f32_16x16x32_bf16 v[88:91], v[204:207], v[236:239], v[88:91]
  ds_read_b128 v[184:187], v24 offset:3136
  buffer_load_dwordx4 v29, s[16:19], s59 offen offset:1024 lds
  v_mfma_f32_16x16x32_bf16 v[92:95], v[204:207], v[240:243], v[92:95]
  ds_read2_b32 v[152:153], v23 offset0:128 offset1:129
  v_mfma_f32_16x16x32_bf16 v[80:83], v[208:211], v[224:227], v[80:83]
  ds_read2_b32 v[154:155], v23 offset0:130 offset1:131
  v_mfma_f32_16x16x32_bf16 v[84:87], v[208:211], v[228:231], v[84:87]
  ds_read_b128 v[188:191], v24 offset:3648
  ds_read_b64_tr_b16 a[32:33], v32 offset:0
  ds_read_b64_tr_b16 a[34:35], v32 offset:1024
  ds_read_b64_tr_b16 a[36:37], v33 offset:0
  ds_read_b64_tr_b16 a[38:39], v33 offset:1024
  v_mfma_f32_16x16x32_bf16 v[88:91], v[208:211], v[232:235], v[88:91]
  ds_read2_b32 v[156:157], v23 offset0:0 offset1:1
  v_mfma_f32_16x16x32_bf16 v[92:95], v[208:211], v[236:239], v[92:95]
  ds_read2_b32 v[158:159], v23 offset0:2 offset1:3
  v_mfma_f32_16x16x32_bf16 v[84:87], v[212:215], v[224:227], v[84:87]
  v_mfma_f32_16x16x32_bf16 v[88:91], v[212:215], v[228:231], v[88:91]
  s_waitcnt lgkmcnt(2)
  s_add_u32 m0, s93, 0
  s_add_u32 s59, s92, 262144
  buffer_load_dwordx4 v28, s[16:19], s59 offen lds
  v_mfma_f32_16x16x32_bf16 v[92:95], v[212:215], v[232:235], v[92:95]
  v_mfma_f32_16x16x32_bf16 v[88:91], v[216:219], v[224:227], v[88:91]
  v_mfma_f32_16x16x32_bf16 v[92:95], v[216:219], v[228:231], v[92:95]
  v_mfma_f32_16x16x32_bf16 v[92:95], v[220:223], v[224:227], v[92:95]
  buffer_load_dwordx4 v29, s[16:19], s59 offen offset:1024 lds
  v_subrev_u32 v20, 64, v20
  v_subrev_u32 v21, 64, v21
  v_subrev_u32 v22, 64, v22
  v_subrev_u32 v23, 64, v23
  v_mfma_f32_16x16x32_bf16 v[64:67], v[128:131], v[160:163], v[64:67]
  v_mfma_f32_16x16x32_bf16 v[68:71], v[128:131], v[164:167], v[68:71]
  v_mfma_f32_16x16x32_bf16 v[72:75], v[128:131], v[168:171], v[72:75]
  ds_read_b64_tr_b16 a[40:41], v32 offset:2048
  ds_read_b64_tr_b16 a[42:43], v32 offset:3072
  ds_read_b64_tr_b16 a[44:45], v33 offset:2048
  ds_read_b64_tr_b16 a[46:47], v33 offset:3072
  v_mfma_f32_16x16x32_bf16 v[76:79], v[128:131], v[172:175], v[76:79]
  v_mfma_f32_16x16x32_bf16 v[80:83], v[128:131], v[176:179], v[80:83]
  v_mfma_f32_16x16x32_bf16 v[84:87], v[128:131], v[180:183], v[84:87]
  v_mfma_f32_16x16x32_bf16 v[88:91], v[128:131], v[184:187], v[88:91]
  ds_read_b128 v[224:227], v24 offset:0
  s_waitcnt lgkmcnt(1)
  s_add_u32 m0, s93, 2048
  s_add_u32 s59, s92, 278528
  buffer_load_dwordx4 v28, s[16:19], s59 offen lds
  v_mfma_f32_16x16x32_bf16 v[92:95], v[128:131], v[188:191], v[92:95]
  ds_read2_b32 v[192:193], v20 offset0:128 offset1:129
  v_mfma_f32_16x16x32_bf16 v[68:71], v[132:135], v[160:163], v[68:71]
  ds_read2_b32 v[194:195], v20 offset0:130 offset1:131
  v_mfma_f32_16x16x32_bf16 v[72:75], v[132:135], v[164:167], v[72:75]
  ds_read_b128 v[228:231], v24 offset:512
  buffer_load_dwordx4 v29, s[16:19], s59 offen offset:1024 lds
  v_mfma_f32_16x16x32_bf16 v[76:79], v[132:135], v[168:171], v[76:79]
  ds_read2_b32 v[196:197], v20 offset0:0 offset1:1
  v_mfma_f32_16x16x32_bf16 v[80:83], v[132:135], v[172:175], v[80:83]
  ds_read2_b32 v[198:199], v20 offset0:2 offset1:3
  v_mfma_f32_16x16x32_bf16 v[84:87], v[132:135], v[176:179], v[84:87]
  ds_read_b128 v[232:235], v24 offset:1024
  ds_read_b64_tr_b16 a[48:49], v32 offset:4096
  ds_read_b64_tr_b16 a[50:51], v32 offset:5120
  ds_read_b64_tr_b16 a[52:53], v33 offset:4096
  ds_read_b64_tr_b16 a[54:55], v33 offset:5120
  v_mfma_f32_16x16x32_bf16 v[88:91], v[132:135], v[180:183], v[88:91]
  ds_read2_b32 v[200:201], v21 offset0:128 offset1:129
  v_mfma_f32_16x16x32_bf16 v[92:95], v[132:135], v[184:187], v[92:95]
  ds_read2_b32 v[202:203], v21 offset0:130 offset1:131
  v_mfma_f32_16x16x32_bf16 v[72:75], v[136:139], v[160:163], v[72:75]
  ds_read_b128 v[236:239], v24 offset:1536
  s_waitcnt lgkmcnt(3)
  s_add_u32 m0, s93, 4096
  s_add_u32 s59, s92, 294912
  buffer_load_dwordx4 v28, s[16:19], s59 offen lds
  v_mfma_f32_16x16x32_bf16 v[76:79], v[136:139], v[164:167], v[76:79]
  ds_read2_b32 v[204:205], v21 offset0:0 offset1:1
  v_mfma_f32_16x16x32_bf16 v[80:83], v[136:139], v[168:171], v[80:83]
  ds_read2_b32 v[206:207], v21 offset0:2 offset1:3
  v_mfma_f32_16x16x32_bf16 v[84:87], v[136:139], v[172:175], v[84:87]
  ds_read_b128 v[240:243], v24 offset:2048
  buffer_load_dwordx4 v29, s[16:19], s59 offen offset:1024 lds
  v_mfma_f32_16x16x32_bf16 v[88:91], v[136:139], v[176:179], v[88:91]
  ds_read2_b32 v[208:209], v22 offset0:128 offset1:129
  v_mfma_f32_16x16x32_bf16 v[92:95], v[136:139], v[180:183], v[92:95]
  ds_read2_b32 v[210:211], v22 offset0:130 offset1:131
  v_mfma_f32_16x16x32_bf16 v[76:79], v[140:143], v[160:163], v[76:79]
  ds_read_b128 v[244:247], v24 offset:2560
  ds_read_b64_tr_b16 a[56:57], v32 offset:6144
  ds_read_b64_tr_b16 a[58:59], v32 offset:7168
  ds_read_b64_tr_b16 a[60:61], v33 offset:6144
  ds_read_b64_tr_b16 a[62:63], v33 offset:7168
  v_mfma_f32_16x16x32_bf16 v[80:83], v[140:143], v[164:167], v[80:83]
  ds_read2_b32 v[212:213], v22 offset0:0 offset1:1
  v_mfma_f32_16x16x32_bf16 v[84:87], v[140:143], v[168:171], v[84:87]
  ds_read2_b32 v[214:215], v22 offset0:2 offset1:3
  v_mfma_f32_16x16x32_bf16 v[88:91], v[140:143], v[172:175], v[88:91]
  ds_read_b128 v[248:251], v24 offset:3072
  s_waitcnt lgkmcnt(3)
  s_add_u32 m0, s93, 6144
  s_add_u32 s59, s92, 311296
  buffer_load_dwordx4 v28, s[16:19], s59 offen lds
  v_mfma_f32_16x16x32_bf16 v[92:95], v[140:143], v[176:179], v[92:95]
  ds_read2_b32 v[216:217], v23 offset0:128 offset1:129
  v_mfma_f32_16x16x32_bf16 v[80:83], v[144:147], v[160:163], v[80:83]
  ds_read2_b32 v[218:219], v23 offset0:130 offset1:131
  v_mfma_f32_16x16x32_bf16 v[84:87], v[144:147], v[164:167], v[84:87]
  ds_read_b128 v[252:255], v24 offset:3584
  buffer_load_dwordx4 v29, s[16:19], s59 offen offset:1024 lds
  v_mfma_f32_16x16x32_bf16 v[88:91], v[144:147], v[168:171], v[88:91]
  ds_read2_b32 v[220:221], v23 offset0:0 offset1:1
  v_mfma_f32_16x16x32_bf16 v[92:95], v[144:147], v[172:175], v[92:95]
  ds_read2_b32 v[222:223], v23 offset0:2 offset1:3
  v_mfma_f32_16x16x32_bf16 v[84:87], v[148:151], v[160:163], v[84:87]
  v_mfma_f32_16x16x32_bf16 v[88:91], v[148:151], v[164:167], v[88:91]
  s_waitcnt vmcnt(22)
  ds_read_b64_tr_b16 a[64:65], v32 offset:32768
  ds_read_b64_tr_b16 a[66:67], v32 offset:33792
  ds_read_b64_tr_b16 a[68:69], v33 offset:32768
  ds_read_b64_tr_b16 a[70:71], v33 offset:33792
  v_mfma_f32_16x16x32_bf16 v[92:95], v[148:151], v[168:171], v[92:95]
  v_mfma_f32_16x16x32_bf16 v[88:91], v[152:155], v[160:163], v[88:91]
  v_mfma_f32_16x16x32_bf16 v[92:95], v[152:155], v[164:167], v[92:95]
  v_mfma_f32_16x16x32_bf16 v[92:95], v[156:159], v[160:163], v[92:95]
  s_waitcnt lgkmcnt(0)
  s_add_u32 m0, s93, 32768
  s_add_u32 s59, s92, 327680
  buffer_load_dwordx4 v28, s[16:19], s59 offen lds
  s_lshr_b32 s53, s45, 1
  s_lshl_b32 s53, s53, 3
  s_lshr_b32 s54, s46, 2
  s_add_u32 s48, s53, s54
  s_and_b32 s53, s45, 1
  s_lshl_b32 s53, s53, 2
  s_and_b32 s54, s46, 3
  s_add_u32 s49, s53, s54
  s_lshr_b32 s53, s48, 1
  s_lshl_b32 s53, s53, 7
  s_add_u32 s53, s53, 0xb10400
  v_min_u32 v61, 13, v1
  v_lshlrev_b32 v61, 2, v61
  v_add_u32 v61, s53, v61
  global_load_dword v60, v61, s[20:21] sc1
  v_mfma_f32_16x16x32_bf16 v[64:67], v[192:195], v[224:227], v[64:67]
  buffer_load_dwordx4 v29, s[16:19], s59 offen offset:1024 lds
  v_mfma_f32_16x16x32_bf16 v[68:71], v[192:195], v[228:231], v[68:71]
  v_mfma_f32_16x16x32_bf16 v[72:75], v[192:195], v[232:235], v[72:75]
  v_mfma_f32_16x16x32_bf16 v[76:79], v[192:195], v[236:239], v[76:79]
  v_mfma_f32_16x16x32_bf16 v[80:83], v[192:195], v[240:243], v[80:83]
  s_waitcnt vmcnt(23)
  ds_read_b64_tr_b16 a[72:73], v32 offset:34816
  ds_read_b64_tr_b16 a[74:75], v32 offset:35840
  ds_read_b64_tr_b16 a[76:77], v33 offset:34816
  ds_read_b64_tr_b16 a[78:79], v33 offset:35840
  v_mfma_f32_16x16x32_bf16 v[84:87], v[192:195], v[244:247], v[84:87]
  v_mfma_f32_16x16x32_bf16 v[88:91], v[192:195], v[248:251], v[88:91]
  v_mfma_f32_16x16x32_bf16 v[92:95], v[192:195], v[252:255], v[92:95]
  v_mfma_f32_16x16x32_bf16 v[68:71], v[196:199], v[224:227], v[68:71]
  s_waitcnt lgkmcnt(0)
  s_add_u32 m0, s93, 34816
  s_add_u32 s59, s92, 344064
  buffer_load_dwordx4 v28, s[16:19], s59 offen lds
  v_mfma_f32_16x16x32_bf16 v[72:75], v[196:199], v[228:231], v[72:75]
  v_mfma_f32_16x16x32_bf16 v[76:79], v[196:199], v[232:235], v[76:79]
  v_mfma_f32_16x16x32_bf16 v[80:83], v[196:199], v[236:239], v[80:83]
  v_mfma_f32_16x16x32_bf16 v[84:87], v[196:199], v[240:243], v[84:87]
  buffer_load_dwordx4 v29, s[16:19], s59 offen offset:1024 lds
  v_mfma_f32_16x16x32_bf16 v[88:91], v[196:199], v[244:247], v[88:91]
  v_mfma_f32_16x16x32_bf16 v[92:95], v[196:199], v[248:251], v[92:95]
  v_mfma_f32_16x16x32_bf16 v[72:75], v[200:203], v[224:227], v[72:75]
  v_mfma_f32_16x16x32_bf16 v[76:79], v[200:203], v[228:231], v[76:79]
  s_waitcnt vmcnt(23)
  ds_read_b64_tr_b16 a[80:81], v32 offset:36864
  ds_read_b64_tr_b16 a[82:83], v32 offset:37888
  ds_read_b64_tr_b16 a[84:85], v33 offset:36864
  ds_read_b64_tr_b16 a[86:87], v33 offset:37888
  v_mfma_f32_16x16x32_bf16 v[80:83], v[200:203], v[232:235], v[80:83]
  v_mfma_f32_16x16x32_bf16 v[84:87], v[200:203], v[236:239], v[84:87]
  v_mfma_f32_16x16x32_bf16 v[88:91], v[200:203], v[240:243], v[88:91]
  v_mfma_f32_16x16x32_bf16 v[92:95], v[200:203], v[244:247], v[92:95]
  s_waitcnt lgkmcnt(0)
  s_add_u32 m0, s93, 36864
  s_add_u32 s59, s92, 360448
  buffer_load_dwordx4 v28, s[16:19], s59 offen lds
  v_mfma_f32_16x16x32_bf16 v[76:79], v[204:207], v[224:227], v[76:79]
  v_mfma_f32_16x16x32_bf16 v[80:83], v[204:207], v[228:231], v[80:83]
  v_mfma_f32_16x16x32_bf16 v[84:87], v[204:207], v[232:235], v[84:87]
  v_mfma_f32_16x16x32_bf16 v[88:91], v[204:207], v[236:239], v[88:91]
  buffer_load_dwordx4 v29, s[16:19], s59 offen offset:1024 lds
  v_mfma_f32_16x16x32_bf16 v[92:95], v[204:207], v[240:243], v[92:95]
  v_mfma_f32_16x16x32_bf16 v[80:83], v[208:211], v[224:227], v[80:83]
  v_mfma_f32_16x16x32_bf16 v[84:87], v[208:211], v[228:231], v[84:87]
  v_mfma_f32_16x16x32_bf16 v[88:91], v[208:211], v[232:235], v[88:91]
  s_waitcnt vmcnt(23)
  ds_read_b64_tr_b16 a[88:89], v32 offset:38912
  ds_read_b64_tr_b16 a[90:91], v32 offset:39936
  ds_read_b64_tr_b16 a[92:93], v33 offset:38912
  ds_read_b64_tr_b16 a[94:95], v33 offset:39936
  v_mfma_f32_16x16x32_bf16 v[92:95], v[208:211], v[236:239], v[92:95]
  v_mfma_f32_16x16x32_bf16 v[84:87], v[212:215], v[224:227], v[84:87]
  v_mfma_f32_16x16x32_bf16 v[88:91], v[212:215], v[228:231], v[88:91]
  v_mfma_f32_16x16x32_bf16 v[92:95], v[212:215], v[232:235], v[92:95]
  s_waitcnt lgkmcnt(0)
  s_add_u32 m0, s93, 38912
  s_add_u32 s59, s92, 376832
  buffer_load_dwordx4 v28, s[16:19], s59 offen lds
  v_mfma_f32_16x16x32_bf16 v[88:91], v[216:219], v[224:227], v[88:91]
  v_mfma_f32_16x16x32_bf16 v[92:95], v[216:219], v[228:231], v[92:95]
  v_mfma_f32_16x16x32_bf16 v[92:95], v[220:223], v[224:227], v[92:95]
  buffer_load_dwordx4 v29, s[16:19], s59 offen offset:1024 lds
  s_waitcnt vmcnt(23)
  ds_read_b64_tr_b16 a[96:97], v30 offset:0
  ds_read_b64_tr_b16 a[98:99], v30 offset:1024
  ds_read_b64_tr_b16 a[100:101], v31 offset:0
  ds_read_b64_tr_b16 a[102:103], v31 offset:1024
  s_waitcnt lgkmcnt(0)
  s_add_u32 m0, s93, 65536
  s_add_u32 s59, s92, 393216
  buffer_load_dwordx4 v28, s[16:19], s59 offen lds
  buffer_load_dwordx4 v29, s[16:19], s59 offen offset:1024 lds
  s_waitcnt vmcnt(23)
  ds_read_b64_tr_b16 a[104:105], v30 offset:2048
  ds_read_b64_tr_b16 a[106:107], v30 offset:3072
  ds_read_b64_tr_b16 a[108:109], v31 offset:2048
  ds_read_b64_tr_b16 a[110:111], v31 offset:3072
  s_waitcnt lgkmcnt(0)
  s_add_u32 m0, s93, 67584
  s_add_u32 s59, s92, 409600
  buffer_load_dwordx4 v28, s[16:19], s59 offen lds
  buffer_load_dwordx4 v29, s[16:19], s59 offen offset:1024 lds
  s_waitcnt vmcnt(23)
  ds_read_b64_tr_b16 a[112:113], v30 offset:4096
  ds_read_b64_tr_b16 a[114:115], v30 offset:5120
  ds_read_b64_tr_b16 a[116:117], v31 offset:4096
  ds_read_b64_tr_b16 a[118:119], v31 offset:5120
  s_waitcnt lgkmcnt(0)
  s_add_u32 m0, s93, 69632
  s_add_u32 s59, s92, 425984
  buffer_load_dwordx4 v28, s[16:19], s59 offen lds
  buffer_load_dwordx4 v29, s[16:19], s59 offen offset:1024 lds
  s_waitcnt vmcnt(23)
  ds_read_b64_tr_b16 a[120:121], v30 offset:6144
  ds_read_b64_tr_b16 a[122:123], v30 offset:7168
  ds_read_b64_tr_b16 a[124:125], v31 offset:6144
  ds_read_b64_tr_b16 a[126:127], v31 offset:7168
  s_waitcnt lgkmcnt(0)
  s_add_u32 m0, s93, 71680
  s_add_u32 s59, s92, 442368
  buffer_load_dwordx4 v28, s[16:19], s59 offen lds
  buffer_load_dwordx4 v29, s[16:19], s59 offen offset:1024 lds
  s_waitcnt vmcnt(15)
  v_cmp_ne_u32 vcc, s47, v60
  s_cbranch_vccnz Lslow_5
Lback_6:
  s_lshl_b32 s53, s48, 1
  s_mul_i32 s53, s53, 112
  s_mul_i32 s54, s44, 28
  s_add_u32 s53, s53, s54
  s_lshl_b32 s53, s53, 10
  s_add_u32 s53, s53, 0x401000
  v_lshlrev_b32 v2, 4, v1
  v_add_u32 v8, s53, v2
  v_add_u32 v9, 114688, v8
  ds_write_b128 v25, v[64:67] offset:0
  global_load_dwordx4 v[128:131], v8, s[20:21] offset:-4096 sc1
  ds_write_b128 v25, v[68:71] offset:1024
  ds_write_b128 v25, v[72:75] offset:2048
  ds_write_b128 v25, v[76:79] offset:3072
  ds_write_b128 v25, v[80:83] offset:4096
  ds_write_b128 v25, v[84:87] offset:5120
  ds_write_b128 v25, v[88:91] offset:6144
  ds_write_b128 v25, v[92:95] offset:7168
  s_waitcnt lgkmcnt(0)
  s_barrier
  ds_read_b128 v[96:99], v26 offset:0
  ds_read_b128 v[100:103], v27 offset:0
  ds_read_b128 v[104:107], v26 offset:8192
  ds_read_b128 v[108:111], v27 offset:8192
  ds_read_b128 v[112:115], v58 offset:0
  global_load_dwordx4 v[132:135], v9, s[20:21] offset:-4096 sc1
  ds_read_b128 v[34:37], v26 offset:2048
  ds_read_b128 v[38:41], v27 offset:2048
  ds_read_b128 v[42:45], v26 offset:10240
  ds_read_b128 v[46:49], v27 offset:10240
  ds_read_b128 v[50:53], v58 offset:1024
  s_waitcnt lgkmcnt(7)
  v_add_f32 v96, v96, v104
  v_add_f32 v97, v97, v105
  v_add_f32 v98, v98, v106
  v_add_f32 v99, v99, v107
  s_waitcnt lgkmcnt(6)
  v_add_f32 v100, v100, v108
  v_add_f32 v101, v101, v109
  v_add_f32 v102, v102, v110
  v_add_f32 v103, v103, v111
  global_load_dwordx4 v[136:139], v8, s[20:21] offset:-3072 sc1
  s_waitcnt lgkmcnt(5)
  v_lshlrev_b32 v2, 16, v112
  v_and_b32 v3, 0xffff0000, v112
  v_fmac_f32 v96, v2, v17
  v_fmac_f32 v97, v3, v17
  v_lshlrev_b32 v2, 16, v113
  v_and_b32 v3, 0xffff0000, v113
  v_fmac_f32 v98, v2, v17
  v_fmac_f32 v99, v3, v17
  v_lshlrev_b32 v2, 16, v114
  v_and_b32 v3, 0xffff0000, v114
  v_fmac_f32 v100, v2, v17
  v_fmac_f32 v101, v3, v17
  v_lshlrev_b32 v2, 16, v115
  v_and_b32 v3, 0xffff0000, v115
  v_fmac_f32 v102, v2, v17
  v_fmac_f32 v103, v3, v17
  global_load_dwordx4 v[140:143], v9, s[20:21] offset:-3072 sc1
  v_cvt_pk_bf16_f32 v104, v96, v97
  v_cvt_pk_bf16_f32 v105, v98, v99
  v_cvt_pk_bf16_f32 v106, v100, v101
  v_cvt_pk_bf16_f32 v107, v102, v103
  global_store_dwordx4 v59, v[104:107], s[20:21] offset:0 sc1
  global_load_dwordx4 v[144:147], v8, s[20:21] offset:-2048 sc1
  s_waitcnt lgkmcnt(2)
  v_add_f32 v34, v34, v42
  v_add_f32 v35, v35, v43
  v_add_f32 v36, v36, v44
  v_add_f32 v37, v37, v45
  s_waitcnt lgkmcnt(1)
  v_add_f32 v38, v38, v46
  v_add_f32 v39, v39, v47
  v_add_f32 v40, v40, v48
  v_add_f32 v41, v41, v49
  global_load_dwordx4 v[148:151], v9, s[20:21] offset:-2048 sc1
  s_waitcnt lgkmcnt(0)
  v_lshlrev_b32 v2, 16, v50
  v_and_b32 v3, 0xffff0000, v50
  v_fmac_f32 v34, v2, v17
  v_fmac_f32 v35, v3, v17
  v_lshlrev_b32 v2, 16, v51
  v_and_b32 v3, 0xffff0000, v51
  v_fmac_f32 v36, v2, v17
  v_fmac_f32 v37, v3, v17
  v_lshlrev_b32 v2, 16, v52
  v_and_b32 v3, 0xffff0000, v52
  v_fmac_f32 v38, v2, v17
  v_fmac_f32 v39, v3, v17
  v_lshlrev_b32 v2, 16, v53
  v_and_b32 v3, 0xffff0000, v53
  v_fmac_f32 v40, v2, v17
  v_fmac_f32 v41, v3, v17
  global_load_dwordx4 v[152:155], v8, s[20:21] offset:-1024 sc1
  v_cvt_pk_bf16_f32 v42, v34, v35
  v_cvt_pk_bf16_f32 v43, v36, v37
  v_cvt_pk_bf16_f32 v44, v38, v39
  v_cvt_pk_bf16_f32 v45, v40, v41
  global_store_dwordx4 v59, v[42:45], s[20:21] offset:1024 sc1
  global_load_dwordx4 v[156:159], v9, s[20:21] offset:-1024 sc1
  global_load_dwordx4 v[160:163], v8, s[20:21] offset:0 sc1
  global_load_dwordx4 v[164:167], v9, s[20:21] offset:0 sc1
  global_load_dwordx4 v[168:171], v8, s[20:21] offset:1024 sc1
  global_load_dwordx4 v[172:175], v9, s[20:21] offset:1024 sc1
  global_load_dwordx4 v[176:179], v8, s[20:21] offset:2048 sc1
  global_load_dwordx4 v[180:183], v9, s[20:21] offset:2048 sc1
  global_load_dwordx4 v[184:187], v8, s[20:21] offset:3072 sc1
  global_load_dwordx4 v[188:191], v9, s[20:21] offset:3072 sc1
  v_add_u32 v8, 8192, v8
  v_add_u32 v9, 8192, v9
  global_load_dwordx4 v[192:195], v8, s[20:21] offset:-4096 sc1
  global_load_dwordx4 v[196:199], v9, s[20:21] offset:-4096 sc1
  global_load_dwordx4 v[200:203], v8, s[20:21] offset:-3072 sc1
  global_load_dwordx4 v[204:207], v9, s[20:21] offset:-3072 sc1
  s_lshl_b32 s53, s49, 7
  s_add_u32 s53, s53, 0xb11000
  v_min_u32 v23, 31, v1
  v_lshlrev_b32 v23, 2, v23
  v_add_u32 v23, s53, v23
  s_waitcnt vmcnt(21)
  v_mfma_f32_32x32x16_bf16 v[64:79], a[0:3], v[128:131], 0
  global_load_dwordx4 v[208:211], v8, s[20:21] offset:-2048 sc1
  s_waitcnt vmcnt(21)
  v_mfma_f32_32x32x16_bf16 v[80:95], a[0:3], v[132:135], 0
  v_mfma_f32_32x32x16_bf16 v[96:111], a[4:7], v[128:131], 0
  global_load_dwordx4 v[212:215], v9, s[20:21] offset:-2048 sc1
  v_mfma_f32_32x32x16_bf16 v[112:127], a[4:7], v[132:135], 0
  s_waitcnt vmcnt(15)
  s_barrier
  s_lshl_b32 s53, s45, 7
  s_lshl_b32 s54, s46, 2
  s_add_u32 s53, s53, s54
  s_add_u32 s53, s53, 0xb11000
  s_cmp_lg_u32 s44, 0
  s_cbranch_scc1 Lnoflag_7
  v_mov_b32 v62, s53
  v_mov_b32 v63, s47
  s_mov_b64 s[88:89], exec
  s_mov_b64 exec, 1
  global_store_dword v62, v63, s[20:21] sc1
  s_mov_b64 exec, s[88:89]
Lnoflag_7:
  v_mfma_f32_32x32x16_bf16 v[64:79], a[8:11], v[136:139], v[64:79]
  global_load_dwordx4 v[216:219], v8, s[20:21] offset:-1024 sc1
  v_mfma_f32_32x32x16_bf16 v[80:95], a[8:11], v[140:143], v[80:95]
  v_lshlrev_b32 v21, 4, v1
  v_add_u32 v21, 98304, v21
  s_mul_i32 s53, s44, 12288
  v_mfma_f32_32x32x16_bf16 v[96:111], a[12:15], v[136:139], v[96:111]
  global_load_dwordx4 v[220:223], v9, s[20:21] offset:-1024 sc1
  v_mfma_f32_32x32x16_bf16 v[112:127], a[12:15], v[140:143], v[112:127]
  v_add_u32 v39, s53, v21
  v_lshrrev_b32 v2, 3, v1
  v_and_b32 v3, 7, v1
  v_mfma_f32_32x32x16_bf16 v[64:79], a[16:19], v[144:147], v[64:79]
  global_load_dwordx4 v[224:227], v8, s[20:21] offset:0 sc1
  v_mfma_f32_32x32x16_bf16 v[80:95], a[16:19], v[148:151], v[80:95]
  v_lshrrev_b32 v4, 1, v2
  v_and_b32 v4, 1, v4
  v_lshlrev_b32 v4, 2, v4
  v_mfma_f32_32x32x16_bf16 v[96:111], a[20:23], v[144:147], v[96:111]
  global_load_dwordx4 v[228:231], v9, s[20:21] offset:0 sc1
  v_mfma_f32_32x32x16_bf16 v[112:127], a[20:23], v[148:151], v[112:127]
  v_xor_b32 v4, v4, v3
  v_lshlrev_b32 v4, 4, v4
  v_lshl_add_u32 v4, v2, 7, v4
  v_mfma_f32_32x32x16_bf16 v[64:79], a[24:27], v[152:155], v[64:79]
  global_load_dwordx4 v[232:235], v8, s[20:21] offset:1024 sc1
  s_waitcnt vmcnt(19)
  v_mfma_f32_32x32x16_bf16 v[80:95], a[24:27], v[156:159], v[80:95]
  s_lshl_b32 s53, s44, 11
  s_add_u32 s53, s53, 147456
  v_add_u32 v38, s53, v4
  v_mfma_f32_32x32x16_bf16 v[96:111], a[28:31], v[152:155], v[96:111]
  global_load_dwordx4 v[236:239], v9, s[20:21] offset:1024 sc1
  v_mfma_f32_32x32x16_bf16 v[112:127], a[28:31], v[156:159], v[112:127]
  v_xor_b32 v4, v3, v2
  v_lshlrev_b32 v4, 4, v4
  v_lshl_add_u32 v4, v2, 7, v4
  s_waitcnt vmcnt(19)
  v_mfma_f32_32x32x16_bf16 v[64:79], a[32:35], v[160:163], v[64:79]
  ds_read_b64_tr_b16 a[128:129], v32 offset:0
  ds_read_b64_tr_b16 a[130:131], v32 offset:1024
  ds_read_b64_tr_b16 a[132:133], v33 offset:0
  ds_read_b64_tr_b16 a[134:135], v33 offset:1024
  global_load_dwordx4 v[240:243], v8, s[20:21] offset:2048 sc1
  s_waitcnt vmcnt(19)
  v_mfma_f32_32x32x16_bf16 v[80:95], a[32:35], v[164:167], v[80:95]
  s_lshl_b32 s53, s44, 11
  s_add_u32 s53, s53, 155648
  v_add_u32 v36, s53, v4
  v_mfma_f32_32x32x16_bf16 v[96:111], a[36:39], v[160:163], v[96:111]
  global_load_dwordx4 v[244:247], v9, s[20:21] offset:2048 sc1
  v_mfma_f32_32x32x16_bf16 v[112:127], a[36:39], v[164:167], v[112:127]
  s_lshl_b32 s53, s48, 6
  s_lshl_b32 s54, s44, 4
  s_add_u32 s53, s53, s54
  s_waitcnt vmcnt(19)
  v_mfma_f32_32x32x16_bf16 v[64:79], a[40:43], v[168:171], v[64:79]
  ds_read_b64_tr_b16 a[136:137], v32 offset:2048
  ds_read_b64_tr_b16 a[138:139], v32 offset:3072
  ds_read_b64_tr_b16 a[140:141], v33 offset:2048
  ds_read_b64_tr_b16 a[142:143], v33 offset:3072
  global_load_dwordx4 v[248:251], v8, s[20:21] offset:3072 sc1
  s_waitcnt vmcnt(19)
  v_mfma_f32_32x32x16_bf16 v[80:95], a[40:43], v[172:175], v[80:95]
  s_lshl_b32 s53, s53, 10
  s_lshl_b32 s54, s49, 7
  s_add_u32 s53, s53, s54
  v_mfma_f32_32x32x16_bf16 v[96:111], a[44:47], v[168:171], v[96:111]
  global_load_dwordx4 v[252:255], v9, s[20:21] offset:3072 sc1
  v_mfma_f32_32x32x16_bf16 v[112:127], a[44:47], v[172:175], v[112:127]
  v_lshlrev_b32 v5, 10, v2
  v_lshl_add_u32 v5, v3, 4, v5
  v_add_u32 v37, s53, v5
  s_waitcnt vmcnt(19)
  v_mfma_f32_32x32x16_bf16 v[64:79], a[48:51], v[176:179], v[64:79]
  ds_read_b64_tr_b16 a[144:145], v32 offset:4096
  ds_read_b64_tr_b16 a[146:147], v32 offset:5120
  ds_read_b64_tr_b16 a[148:149], v33 offset:4096
  ds_read_b64_tr_b16 a[150:151], v33 offset:5120
  v_add_u32 v8, 8192, v8
  v_add_u32 v9, 8192, v9
  global_load_dwordx4 v[128:131], v8, s[20:21] offset:-4096 sc1
  s_waitcnt vmcnt(19)
  v_mfma_f32_32x32x16_bf16 v[80:95], a[48:51], v[180:183], v[80:95]
  v_lshrrev_b32 v2, 5, v1
  v_lshrrev_b32 v3, 2, v1
  v_and_b32 v3, 3, v3
  v_mfma_f32_32x32x16_bf16 v[96:111], a[52:55], v[176:179], v[96:111]
  global_load_dwordx4 v[132:135], v9, s[20:21] offset:-4096 sc1
  v_mfma_f32_32x32x16_bf16 v[112:127], a[52:55], v[180:183], v[112:127]
  v_lshl_add_u32 v2, v2, 2, v3
  v_lshlrev_b32 v2, 7, v2
  v_lshrrev_b32 v3, 1, v3
  s_waitcnt vmcnt(19)
  v_mfma_f32_32x32x16_bf16 v[64:79], a[56:59], v[184:187], v[64:79]
  ds_read_b64_tr_b16 a[152:153], v32 offset:6144
  ds_read_b64_tr_b16 a[154:155], v32 offset:7168
  ds_read_b64_tr_b16 a[156:157], v33 offset:6144
  ds_read_b64_tr_b16 a[158:159], v33 offset:7168
  global_load_dwordx4 v[136:139], v8, s[20:21] offset:-3072 sc1
  s_waitcnt vmcnt(19)
  v_mfma_f32_32x32x16_bf16 v[80:95], a[56:59], v[188:191], v[80:95]
  s_lshr_b32 s54, s44, 1
  v_xor_b32 v3, s54, v3
  v_lshl_add_u32 v2, v3, 6, v2
  v_mfma_f32_32x32x16_bf16 v[96:111], a[60:63], v[184:187], v[96:111]
  global_load_dwordx4 v[140:143], v9, s[20:21] offset:-3072 sc1
  v_mfma_f32_32x32x16_bf16 v[112:127], a[60:63], v[188:191], v[112:127]
  v_lshrrev_b32 v3, 4, v1
  v_and_b32 v3, 1, v3
  v_lshl_add_u32 v2, v3, 5, v2
  s_waitcnt vmcnt(19)
  v_mfma_f32_32x32x16_bf16 v[64:79], a[64:67], v[192:195], v[64:79]
  ds_read_b64_tr_b16 a[160:161], v32 offset:32768
  ds_read_b64_tr_b16 a[162:163], v32 offset:33792
  ds_read_b64_tr_b16 a[164:165], v33 offset:32768
  ds_read_b64_tr_b16 a[166:167], v33 offset:33792
  global_load_dwordx4 v[144:147], v8, s[20:21] offset:-2048 sc1
  s_waitcnt vmcnt(19)
  v_mfma_f32_32x32x16_bf16 v[80:95], a[64:67], v[196:199], v[80:95]
  v_and_b32 v3, 3, v1
  v_lshl_add_u32 v2, v3, 3, v2
  s_and_b32 s53, s44, 1
  v_mfma_f32_32x32x16_bf16 v[96:111], a[68:71], v[192:195], v[96:111]
  global_load_dwordx4 v[148:151], v9, s[20:21] offset:-2048 sc1
  v_mfma_f32_32x32x16_bf16 v[112:127], a[68:71], v[196:199], v[112:127]
  s_lshl_b32 s53, s53, 12
  s_add_u32 s53, s53, 147456
  v_add_u32 v22, s53, v2
  s_waitcnt vmcnt(19)
  v_mfma_f32_32x32x16_bf16 v[64:79], a[72:75], v[200:203], v[64:79]
  ds_read_b64_tr_b16 a[168:169], v32 offset:34816
  ds_read_b64_tr_b16 a[170:171], v32 offset:35840
  ds_read_b64_tr_b16 a[172:173], v33 offset:34816
  ds_read_b64_tr_b16 a[174:175], v33 offset:35840
  global_load_dwordx4 v[152:155], v8, s[20:21] offset:-1024 sc1
  s_waitcnt vmcnt(19)
  v_mfma_f32_32x32x16_bf16 v[80:95], a[72:75], v[204:207], v[80:95]
  v_and_b32 v2, 31, v1
  s_lshr_b32 s54, s44, 1
  s_lshl_b32 s54, s54, 12
  v_mfma_f32_32x32x16_bf16 v[96:111], a[76:79], v[200:203], v[96:111]
  global_load_dwordx4 v[156:159], v9, s[20:21] offset:-1024 sc1
  v_mfma_f32_32x32x16_bf16 v[112:127], a[76:79], v[204:207], v[112:127]
  v_lshlrev_b32 v3, 7, v2
  v_add_u32 v3, s54, v3
  v_lshrrev_b32 v4, 5, v1
  s_waitcnt vmcnt(19)
  v_mfma_f32_32x32x16_bf16 v[64:79], a[80:83], v[208:211], v[64:79]
  ds_read_b64_tr_b16 a[176:177], v32 offset:36864
  ds_read_b64_tr_b16 a[178:179], v32 offset:37888
  ds_read_b64_tr_b16 a[180:181], v33 offset:36864
  ds_read_b64_tr_b16 a[182:183], v33 offset:37888
  global_load_dwordx4 v[160:163], v8, s[20:21] offset:0 sc1
  s_waitcnt vmcnt(19)
  v_mfma_f32_32x32x16_bf16 v[80:95], a[80:83], v[212:215], v[80:95]
  v_lshl_add_u32 v3, v4, 3, v3
  v_add_u32 v3, 155648, v3
  v_and_b32 v2, 7, v2
  v_mfma_f32_32x32x16_bf16 v[96:111], a[84:87], v[208:211], v[96:111]
  global_load_dwordx4 v[164:167], v9, s[20:21] offset:0 sc1
  v_mfma_f32_32x32x16_bf16 v[112:127], a[84:87], v[212:215], v[112:127]
  s_and_b32 s53, s44, 1
  s_lshl_b32 s53, s53, 2
  s_add_u32 s54, s53, 0
  s_waitcnt vmcnt(19)
  v_mfma_f32_32x32x16_bf16 v[64:79], a[88:91], v[216:219], v[64:79]
  ds_read_b64_tr_b16 a[184:185], v32 offset:38912
  ds_read_b64_tr_b16 a[186:187], v32 offset:39936
  ds_read_b64_tr_b16 a[188:189], v33 offset:38912
  ds_read_b64_tr_b16 a[190:191], v33 offset:39936
  global_load_dwordx4 v[168:171], v8, s[20:21] offset:1024 sc1
  s_waitcnt vmcnt(19)
  v_mfma_f32_32x32x16_bf16 v[80:95], a[88:91], v[220:223], v[80:95]
  v_xor_b32 v4, s54, v2
  v_lshl_add_u32 v48, v4, 4, v3
  s_add_u32 s54, s53, 1
  v_mfma_f32_32x32x16_bf16 v[96:111], a[92:95], v[216:219], v[96:111]
  global_load_dwordx4 v[172:175], v9, s[20:21] offset:1024 sc1
  v_mfma_f32_32x32x16_bf16 v[112:127], a[92:95], v[220:223], v[112:127]
  v_xor_b32 v4, s54, v2
  v_lshl_add_u32 v49, v4, 4, v3
  s_add_u32 s54, s53, 2
  s_waitcnt vmcnt(19)
  v_mfma_f32_32x32x16_bf16 v[64:79], a[96:99], v[224:227], v[64:79]
  ds_read_b64_tr_b16 a[192:193], v30 offset:0
  ds_read_b64_tr_b16 a[194:195], v30 offset:1024
  ds_read_b64_tr_b16 a[196:197], v31 offset:0
  ds_read_b64_tr_b16 a[198:199], v31 offset:1024
  global_load_dwordx4 v[176:179], v8, s[20:21] offset:2048 sc1
  s_waitcnt vmcnt(19)
  v_mfma_f32_32x32x16_bf16 v[80:95], a[96:99], v[228:231], v[80:95]
  v_xor_b32 v4, s54, v2
  v_lshl_add_u32 v50, v4, 4, v3
  s_add_u32 s54, s53, 3
  v_mfma_f32_32x32x16_bf16 v[96:111], a[100:103], v[224:227], v[96:111]
  global_load_dwordx4 v[180:183], v9, s[20:21] offset:2048 sc1
  v_mfma_f32_32x32x16_bf16 v[112:127], a[100:103], v[228:231], v[112:127]
  v_xor_b32 v4, s54, v2
  v_lshl_add_u32 v51, v4, 4, v3
  s_waitcnt vmcnt(19)
  v_mfma_f32_32x32x16_bf16 v[64:79], a[104:107], v[232:235], v[64:79]
  ds_read_b64_tr_b16 a[200:201], v30 offset:2048
  ds_read_b64_tr_b16 a[202:203], v30 offset:3072
  ds_read_b64_tr_b16 a[204:205], v31 offset:2048
  ds_read_b64_tr_b16 a[206:207], v31 offset:3072
  global_load_dwordx4 v[184:187], v8, s[20:21] offset:3072 sc1
  s_waitcnt vmcnt(19)
  v_mfma_f32_32x32x16_bf16 v[80:95], a[104:107], v[236:239], v[80:95]
  v_mfma_f32_32x32x16_bf16 v[96:111], a[108:111], v[232:235], v[96:111]
  global_load_dwordx4 v[188:191], v9, s[20:21] offset:3072 sc1
  v_mfma_f32_32x32x16_bf16 v[112:127], a[108:111], v[236:239], v[112:127]
  s_waitcnt vmcnt(19)
  v_mfma_f32_32x32x16_bf16 v[64:79], a[112:115], v[240:243], v[64:79]
  ds_read_b64_tr_b16 a[208:209], v30 offset:4096
  ds_read_b64_tr_b16 a[210:211], v30 offset:5120
  ds_read_b64_tr_b16 a[212:213], v31 offset:4096
  ds_read_b64_tr_b16 a[214:215], v31 offset:5120
  v_add_u32 v8, 8192, v8
  v_add_u32 v9, 8192, v9
  global_load_dwordx4 v[192:195], v8, s[20:21] offset:-4096 sc1
  s_waitcnt vmcnt(19)
  v_mfma_f32_32x32x16_bf16 v[80:95], a[112:115], v[244:247], v[80:95]
  v_mfma_f32_32x32x16_bf16 v[96:111], a[116:119], v[240:243], v[96:111]
  global_load_dwordx4 v[196:199], v9, s[20:21] offset:-4096 sc1
  v_mfma_f32_32x32x16_bf16 v[112:127], a[116:119], v[244:247], v[112:127]
  s_waitcnt vmcnt(19)
  v_mfma_f32_32x32x16_bf16 v[64:79], a[120:123], v[248:251], v[64:79]
  ds_read_b64_tr_b16 a[216:217], v30 offset:6144
  ds_read_b64_tr_b16 a[218:219], v30 offset:7168
  ds_read_b64_tr_b16 a[220:221], v31 offset:6144
  ds_read_b64_tr_b16 a[222:223], v31 offset:7168
  global_load_dwordx4 v[200:203], v8, s[20:21] offset:-3072 sc1
  s_waitcnt vmcnt(19)
  v_mfma_f32_32x32x16_bf16 v[80:95], a[120:123], v[252:255], v[80:95]
  v_mfma_f32_32x32x16_bf16 v[96:111], a[124:127], v[248:251], v[96:111]
  global_load_dwordx4 v[204:207], v9, s[20:21] offset:-3072 sc1
  v_mfma_f32_32x32x16_bf16 v[112:127], a[124:127], v[252:255], v[112:127]
  s_waitcnt vmcnt(19) lgkmcnt(15)
  v_mfma_f32_32x32x16_bf16 v[64:79], a[128:131], v[128:131], v[64:79]
  global_load_dwordx4 v[208:211], v8, s[20:21] offset:-2048 sc1
  s_waitcnt vmcnt(19)
  v_mfma_f32_32x32x16_bf16 v[80:95], a[128:131], v[132:135], v[80:95]
  v_mfma_f32_32x32x16_bf16 v[96:111], a[132:135], v[128:131], v[96:111]
  global_load_dwordx4 v[212:215], v9, s[20:21] offset:-2048 sc1
  v_mfma_f32_32x32x16_bf16 v[112:127], a[132:135], v[132:135], v[112:127]
  s_waitcnt vmcnt(19)
  v_mfma_f32_32x32x16_bf16 v[64:79], a[136:139], v[136:139], v[64:79]
  global_load_dwordx4 v[216:219], v8, s[20:21] offset:-1024 sc1
  s_waitcnt vmcnt(19)
  v_mfma_f32_32x32x16_bf16 v[80:95], a[136:139], v[140:143], v[80:95]
  v_mfma_f32_32x32x16_bf16 v[96:111], a[140:143], v[136:139], v[96:111]
  global_load_dwordx4 v[220:223], v9, s[20:21] offset:-1024 sc1
  v_mfma_f32_32x32x16_bf16 v[112:127], a[140:143], v[140:143], v[112:127]
  s_waitcnt vmcnt(19)
  v_mfma_f32_32x32x16_bf16 v[64:79], a[144:147], v[144:147], v[64:79]
  s_waitcnt vmcnt(18)
  v_mfma_f32_32x32x16_bf16 v[80:95], a[144:147], v[148:151], v[80:95]
  v_mfma_f32_32x32x16_bf16 v[96:111], a[148:151], v[144:147], v[96:111]
  v_mfma_f32_32x32x16_bf16 v[112:127], a[148:151], v[148:151], v[112:127]
  s_waitcnt vmcnt(17)
  v_mfma_f32_32x32x16_bf16 v[64:79], a[152:155], v[152:155], v[64:79]
  s_waitcnt vmcnt(16)
  v_mfma_f32_32x32x16_bf16 v[80:95], a[152:155], v[156:159], v[80:95]
  v_mfma_f32_32x32x16_bf16 v[96:111], a[156:159], v[152:155], v[96:111]
  v_mfma_f32_32x32x16_bf16 v[112:127], a[156:159], v[156:159], v[112:127]
  s_waitcnt vmcnt(15)
  v_mfma_f32_32x32x16_bf16 v[64:79], a[160:163], v[160:163], v[64:79]
  s_waitcnt vmcnt(14)
  v_mfma_f32_32x32x16_bf16 v[80:95], a[160:163], v[164:167], v[80:95]
  v_mfma_f32_32x32x16_bf16 v[96:111], a[164:167], v[160:163], v[96:111]
  v_mfma_f32_32x32x16_bf16 v[112:127], a[164:167], v[164:167], v[112:127]
  global_load_dword v24, v23, s[20:21] sc1
  s_waitcnt vmcnt(14)
  v_mfma_f32_32x32x16_bf16 v[64:79], a[168:171], v[168:171], v[64:79]
  s_waitcnt vmcnt(13)
  v_mfma_f32_32x32x16_bf16 v[80:95], a[168:171], v[172:175], v[80:95]
  v_mfma_f32_32x32x16_bf16 v[96:111], a[172:175], v[168:171], v[96:111]
  v_mfma_f32_32x32x16_bf16 v[112:127], a[172:175], v[172:175], v[112:127]
  s_waitcnt vmcnt(12)
  v_mfma_f32_32x32x16_bf16 v[64:79], a[176:179], v[176:179], v[64:79]
  s_waitcnt vmcnt(11)
  v_mfma_f32_32x32x16_bf16 v[80:95], a[176:179], v[180:183], v[80:95]
  v_mfma_f32_32x32x16_bf16 v[96:111], a[180:183], v[176:179], v[96:111]
  v_mfma_f32_32x32x16_bf16 v[112:127], a[180:183], v[180:183], v[112:127]
  s_waitcnt vmcnt(10)
  v_mfma_f32_32x32x16_bf16 v[64:79], a[184:187], v[184:187], v[64:79]
  s_waitcnt vmcnt(9)
  v_mfma_f32_32x32x16_bf16 v[80:95], a[184:187], v[188:191], v[80:95]
  v_mfma_f32_32x32x16_bf16 v[96:111], a[188:191], v[184:187], v[96:111]
  v_mfma_f32_32x32x16_bf16 v[112:127], a[188:191], v[188:191], v[112:127]
  s_waitcnt vmcnt(8) lgkmcnt(14)
  v_mfma_f32_32x32x16_bf16 v[64:79], a[192:195], v[192:195], v[64:79]
  s_waitcnt vmcnt(7)
  v_mfma_f32_32x32x16_bf16 v[80:95], a[192:195], v[196:199], v[80:95]
  s_waitcnt lgkmcnt(12)
  v_mfma_f32_32x32x16_bf16 v[96:111], a[196:199], v[192:195], v[96:111]
  v_mfma_f32_32x32x16_bf16 v[112:127], a[196:199], v[196:199], v[112:127]
  s_waitcnt vmcnt(0)
  v_cmp_ne_u32 vcc, s47, v24
  s_cbranch_vccnz Lslow_8
Lback_9:
  s_lshl_b32 s53, s49, 6
  s_lshl_b32 s54, s44, 4
  s_add_u32 s53, s53, s54
  s_lshl_b32 s53, s53, 12
  s_lshl_b32 s54, s48, 7
  s_add_u32 s53, s53, s54
  s_add_u32 s53, s53, 0x200000
  v_lshrrev_b32 v2, 3, v1
  v_and_b32 v3, 7, v1
  v_lshlrev_b32 v6, 12, v2
  v_lshl_add_u32 v6, v3, 4, v6
  v_add_u32 v6, s53, v6
  global_load_dwordx4 v[40:43], v6, s[20:21] sc1
  v_add_u32 v6, 32768, v6
  global_load_dwordx4 v[44:47], v6, s[20:21] sc1
  s_lshl_b32 s53, s48, 8
  s_lshr_b32 s54, s44, 1
  s_lshl_b32 s54, s54, 7
  s_add_u32 s53, s53, s54
  s_add_u32 s53, s53, 0xb00000
  v_and_b32 v7, 31, v1
  v_lshlrev_b32 v7, 2, v7
  v_add_u32 v7, s53, v7
  global_load_dword v20, v7, s[20:21] sc1
  v_lshlrev_b32 v25, 4, v1
  v_add_u32 v25, 0xb11000, v25
  global_load_dwordx4 v[28:31], v25, s[20:21] sc1
  s_waitcnt lgkmcnt(10)
  v_mfma_f32_32x32x16_bf16 v[64:79], a[200:203], v[200:203], v[64:79]
  v_mfma_f32_32x32x16_bf16 v[80:95], a[200:203], v[204:207], v[80:95]
  s_waitcnt lgkmcnt(8)
  v_mfma_f32_32x32x16_bf16 v[96:111], a[204:207], v[200:203], v[96:111]
  v_mfma_f32_32x32x16_bf16 v[112:127], a[204:207], v[204:207], v[112:127]
  s_waitcnt lgkmcnt(6)
  v_mfma_f32_32x32x16_bf16 v[64:79], a[208:211], v[208:211], v[64:79]
  v_mfma_f32_32x32x16_bf16 v[80:95], a[208:211], v[212:215], v[80:95]
  s_waitcnt lgkmcnt(4)
  v_mfma_f32_32x32x16_bf16 v[96:111], a[212:215], v[208:211], v[96:111]
  v_mfma_f32_32x32x16_bf16 v[112:127], a[212:215], v[212:215], v[112:127]
  s_waitcnt lgkmcnt(2)
  v_mfma_f32_32x32x16_bf16 v[64:79], a[216:219], v[216:219], v[64:79]
  v_mfma_f32_32x32x16_bf16 v[80:95], a[216:219], v[220:223], v[80:95]
  s_waitcnt lgkmcnt(0)
  v_mfma_f32_32x32x16_bf16 v[96:111], a[220:223], v[216:219], v[96:111]
  v_mfma_f32_32x32x16_bf16 v[112:127], a[220:223], v[220:223], v[112:127]
  s_nop 11
  s_cmp_eq_u32 s44, 1
  s_cbranch_scc1 Lred_11
  s_cmp_eq_u32 s44, 2
  s_cbranch_scc1 Lred_12
  s_cmp_eq_u32 s44, 3
  s_cbranch_scc1 Lred_13
Lred_10:
  ds_write_b128 v21, v[96:99] offset:20480
  ds_write_b128 v21, v[100:103] offset:21504
  ds_write_b128 v21, v[104:107] offset:22528
  ds_write_b128 v21, v[108:111] offset:23552
  ds_write_b128 v21, v[80:83] offset:28672
  ds_write_b128 v21, v[84:87] offset:29696
  ds_write_b128 v21, v[88:91] offset:30720
  ds_write_b128 v21, v[92:95] offset:31744
  ds_write_b128 v21, v[112:115] offset:36864
  ds_write_b128 v21, v[116:119] offset:37888
  ds_write_b128 v21, v[120:123] offset:38912
  ds_write_b128 v21, v[124:127] offset:39936
  v_pk_mov_b32 v[128:129], v[64:65], v[64:65] op_sel:[0,1]
  v_pk_mov_b32 v[130:131], v[66:67], v[66:67] op_sel:[0,1]
  v_pk_mov_b32 v[132:133], v[68:69], v[68:69] op_sel:[0,1]
  v_pk_mov_b32 v[134:135], v[70:71], v[70:71] op_sel:[0,1]
  v_pk_mov_b32 v[136:137], v[72:73], v[72:73] op_sel:[0,1]
  v_pk_mov_b32 v[138:139], v[74:75], v[74:75] op_sel:[0,1]
  v_pk_mov_b32 v[140:141], v[76:77], v[76:77] op_sel:[0,1]
  v_pk_mov_b32 v[142:143], v[78:79], v[78:79] op_sel:[0,1]
  s_branch Lrede_14
Lred_11:
  ds_write_b128 v21, v[64:67] offset:0
  ds_write_b128 v21, v[68:71] offset:1024
  ds_write_b128 v21, v[72:75] offset:2048
  ds_write_b128 v21, v[76:79] offset:3072
  ds_write_b128 v21, v[80:83] offset:32768
  ds_write_b128 v21, v[84:87] offset:33792
  ds_write_b128 v21, v[88:91] offset:34816
  ds_write_b128 v21, v[92:95] offset:35840
  ds_write_b128 v21, v[112:115] offset:40960
  ds_write_b128 v21, v[116:119] offset:41984
  ds_write_b128 v21, v[120:123] offset:43008
  ds_write_b128 v21, v[124:127] offset:44032
  v_pk_mov_b32 v[128:129], v[96:97], v[96:97] op_sel:[0,1]
  v_pk_mov_b32 v[130:131], v[98:99], v[98:99] op_sel:[0,1]
  v_pk_mov_b32 v[132:133], v[100:101], v[100:101] op_sel:[0,1]
  v_pk_mov_b32 v[134:135], v[102:103], v[102:103] op_sel:[0,1]
  v_pk_mov_b32 v[136:137], v[104:105], v[104:105] op_sel:[0,1]
  v_pk_mov_b32 v[138:139], v[106:107], v[106:107] op_sel:[0,1]
  v_pk_mov_b32 v[140:141], v[108:109], v[108:109] op_sel:[0,1]
  v_pk_mov_b32 v[142:143], v[110:111], v[110:111] op_sel:[0,1]
  s_branch Lrede_14
Lred_12:
  ds_write_b128 v21, v[64:67] offset:4096
  ds_write_b128 v21, v[68:71] offset:5120
  ds_write_b128 v21, v[72:75] offset:6144
  ds_write_b128 v21, v[76:79] offset:7168
  ds_write_b128 v21, v[96:99] offset:12288
  ds_write_b128 v21, v[100:103] offset:13312
  ds_write_b128 v21, v[104:107] offset:14336
  ds_write_b128 v21, v[108:111] offset:15360
  ds_write_b128 v21, v[112:115] offset:45056
  ds_write_b128 v21, v[116:119] offset:46080
  ds_write_b128 v21, v[120:123] offset:47104
  ds_write_b128 v21, v[124:127] offset:48128
  v_pk_mov_b32 v[128:129], v[80:81], v[80:81] op_sel:[0,1]
  v_pk_mov_b32 v[130:131], v[82:83], v[82:83] op_sel:[0,1]
  v_pk_mov_b32 v[132:133], v[84:85], v[84:85] op_sel:[0,1]
  v_pk_mov_b32 v[134:135], v[86:87], v[86:87] op_sel:[0,1]
  v_pk_mov_b32 v[136:137], v[88:89], v[88:89] op_sel:[0,1]
  v_pk_mov_b32 v[138:139], v[90:91], v[90:91] op_sel:[0,1]
  v_pk_mov_b32 v[140:141], v[92:93], v[92:93] op_sel:[0,1]
  v_pk_mov_b32 v[142:143], v[94:95], v[94:95] op_sel:[0,1]
  s_branch Lrede_14
Lred_13:
  ds_write_b128 v21, v[64:67] offset:8192
  ds_write_b128 v21, v[68:71] offset:9216
  ds_write_b128 v21, v[72:75] offset:10240
  ds_write_b128 v21, v[76:79] offset:11264
  ds_write_b128 v21, v[96:99] offset:16384
  ds_write_b128 v21, v[100:103] offset:17408
  ds_write_b128 v21, v[104:107] offset:18432
  ds_write_b128 v21, v[108:111] offset:19456
  ds_write_b128 v21, v[80:83] offset:24576
  ds_write_b128 v21, v[84:87] offset:25600
  ds_write_b128 v21, v[88:91] offset:26624
  ds_write_b128 v21, v[92:95] offset:27648
  v_pk_mov_b32 v[128:129], v[112:113], v[112:113] op_sel:[0,1]
  v_pk_mov_b32 v[130:131], v[114:115], v[114:115] op_sel:[0,1]
  v_pk_mov_b32 v[132:133], v[116:117], v[116:117] op_sel:[0,1]
  v_pk_mov_b32 v[134:135], v[118:119], v[118:119] op_sel:[0,1]
  v_pk_mov_b32 v[136:137], v[120:121], v[120:121] op_sel:[0,1]
  v_pk_mov_b32 v[138:139], v[122:123], v[122:123] op_sel:[0,1]
  v_pk_mov_b32 v[140:141], v[124:125], v[124:125] op_sel:[0,1]
  v_pk_mov_b32 v[142:143], v[126:127], v[126:127] op_sel:[0,1]
Lrede_14:
  s_waitcnt vmcnt(3)
  ds_write_b128 v38, v[40:43]
  s_waitcnt vmcnt(2)
  ds_write_b128 v38, v[44:47] offset:1024
  s_waitcnt lgkmcnt(0)
  s_barrier
  ds_read_b128 v[144:147], v39 offset:0
  ds_read_b128 v[160:163], v39 offset:4096
  ds_read_b128 v[176:179], v39 offset:8192
  ds_read_b64_tr_b16 v[192:193], v22 offset:0
  ds_read_b128 v[148:151], v39 offset:1024
  ds_read_b128 v[164:167], v39 offset:5120
  ds_read_b128 v[180:183], v39 offset:9216
  ds_read_b64_tr_b16 v[194:195], v22 offset:1024
  ds_read_b128 v[152:155], v39 offset:2048
  ds_read_b128 v[168:171], v39 offset:6144
  ds_read_b128 v[184:187], v39 offset:10240
  ds_read_b64_tr_b16 v[196:197], v22 offset:2048
  ds_read_b128 v[156:159], v39 offset:3072
  ds_read_b128 v[172:175], v39 offset:7168
  ds_read_b128 v[188:191], v39 offset:11264
  ds_read_b64_tr_b16 v[198:199], v22 offset:3072
  s_waitcnt lgkmcnt(15)
  v_pk_add_f32 v[128:129], v[128:129], v[144:145]
  s_waitcnt lgkmcnt(13)
  v_pk_add_f32 v[160:161], v[160:161], v[176:177]
  v_pk_add_f32 v[130:131], v[130:131], v[146:147]
  v_pk_add_f32 v[162:163], v[162:163], v[178:179]
  s_waitcnt lgkmcnt(12)
  v_lshlrev_b32 v2, 16, v192
  v_and_b32 v3, 0xffff0000, v192
  v_lshlrev_b32 v4, 16, v193
  v_and_b32 v5, 0xffff0000, v193
  v_pk_add_f32 v[128:129], v[128:129], v[160:161]
  v_pk_add_f32 v[130:131], v[130:131], v[162:163]
  v_pk_add_f32 v[2:3], v[2:3], v[128:129] neg_lo:[0,1] neg_hi:[0,1]
  v_pk_add_f32 v[4:5], v[4:5], v[130:131] neg_lo:[0,1] neg_hi:[0,1]
  s_waitcnt vmcnt(1)
  v_pk_fma_f32 v[128:129], v[2:3], v[20:21], v[128:129] op_sel_hi:[1,0,1]
  v_pk_fma_f32 v[130:131], v[4:5], v[20:21], v[130:131] op_sel_hi:[1,0,1]
  v_cvt_pk_bf16_f32 v200, v128, v129
  v_cvt_pk_bf16_f32 v201, v130, v131
  ds_write_b64 v48, v[200:201]
  s_waitcnt lgkmcnt(12)
  v_pk_add_f32 v[132:133], v[132:133], v[148:149]
  s_waitcnt lgkmcnt(10)
  v_pk_add_f32 v[164:165], v[164:165], v[180:181]
  v_pk_add_f32 v[134:135], v[134:135], v[150:151]
  v_pk_add_f32 v[166:167], v[166:167], v[182:183]
  s_waitcnt lgkmcnt(9)
  v_lshlrev_b32 v2, 16, v194
  v_and_b32 v3, 0xffff0000, v194
  v_lshlrev_b32 v4, 16, v195
  v_and_b32 v5, 0xffff0000, v195
  v_pk_add_f32 v[132:133], v[132:133], v[164:165]
  v_pk_add_f32 v[134:135], v[134:135], v[166:167]
  v_pk_add_f32 v[2:3], v[2:3], v[132:133] neg_lo:[0,1] neg_hi:[0,1]
  v_pk_add_f32 v[4:5], v[4:5], v[134:135] neg_lo:[0,1] neg_hi:[0,1]
  v_pk_fma_f32 v[132:133], v[2:3], v[20:21], v[132:133] op_sel_hi:[1,0,1]
  v_pk_fma_f32 v[134:135], v[4:5], v[20:21], v[134:135] op_sel_hi:[1,0,1]
  v_cvt_pk_bf16_f32 v202, v132, v133
  v_cvt_pk_bf16_f32 v203, v134, v135
  ds_write_b64 v49, v[202:203]
  s_waitcnt lgkmcnt(9)
  v_pk_add_f32 v[136:137], v[136:137], v[152:153]
  s_waitcnt lgkmcnt(7)
  v_pk_add_f32 v[168:169], v[168:169], v[184:185]
  v_pk_add_f32 v[138:139], v[138:139], v[154:155]
  v_pk_add_f32 v[170:171], v[170:171], v[186:187]
  s_waitcnt lgkmcnt(6)
  v_lshlrev_b32 v2, 16, v196
  v_and_b32 v3, 0xffff0000, v196
  v_lshlrev_b32 v4, 16, v197
  v_and_b32 v5, 0xffff0000, v197
  v_pk_add_f32 v[136:137], v[136:137], v[168:169]
  v_pk_add_f32 v[138:139], v[138:139], v[170:171]
  v_pk_add_f32 v[2:3], v[2:3], v[136:137] neg_lo:[0,1] neg_hi:[0,1]
  v_pk_add_f32 v[4:5], v[4:5], v[138:139] neg_lo:[0,1] neg_hi:[0,1]
  v_pk_fma_f32 v[136:137], v[2:3], v[20:21], v[136:137] op_sel_hi:[1,0,1]
  v_pk_fma_f32 v[138:139], v[4:5], v[20:21], v[138:139] op_sel_hi:[1,0,1]
  v_cvt_pk_bf16_f32 v204, v136, v137
  v_cvt_pk_bf16_f32 v205, v138, v139
  ds_write_b64 v50, v[204:205]
  s_waitcnt lgkmcnt(6)
  v_pk_add_f32 v[140:141], v[140:141], v[156:157]
  s_waitcnt lgkmcnt(4)
  v_pk_add_f32 v[172:173], v[172:173], v[188:189]
  v_pk_add_f32 v[142:143], v[142:143], v[158:159]
  v_pk_add_f32 v[174:175], v[174:175], v[190:191]
  s_waitcnt lgkmcnt(3)
  v_lshlrev_b32 v2, 16, v198
  v_and_b32 v3, 0xffff0000, v198
  v_lshlrev_b32 v4, 16, v199
  v_and_b32 v5, 0xffff0000, v199
  v_pk_add_f32 v[140:141], v[140:141], v[172:173]
  v_pk_add_f32 v[142:143], v[142:143], v[174:175]
  v_pk_add_f32 v[2:3], v[2:3], v[140:141] neg_lo:[0,1] neg_hi:[0,1]
  v_pk_add_f32 v[4:5], v[4:5], v[142:143] neg_lo:[0,1] neg_hi:[0,1]
  v_pk_fma_f32 v[140:141], v[2:3], v[20:21], v[140:141] op_sel_hi:[1,0,1]
  v_pk_fma_f32 v[142:143], v[4:5], v[20:21], v[142:143] op_sel_hi:[1,0,1]
  v_cvt_pk_bf16_f32 v206, v140, v141
  v_cvt_pk_bf16_f32 v207, v142, v143
  ds_write_b64 v51, v[206:207]
  s_waitcnt lgkmcnt(0)
  s_barrier
  ds_read_b128 v[208:211], v36
  ds_read_b128 v[212:215], v36 offset:1024
  s_waitcnt lgkmcnt(1)
  global_store_dwordx4 v37, v[208:211], s[22:23] sc1
  s_nop 1
  v_add_u32 v37, 8192, v37
  s_waitcnt lgkmcnt(0)
  global_store_dwordx4 v37, v[212:215], s[22:23] sc1
  s_cmp_lg_u32 s2, 0
  s_cbranch_scc1 Lnonce_15
  s_cmp_lg_u32 s44, 0
  s_cbranch_scc1 Lnonce_15
  s_waitcnt vmcnt(2)
  v_cmp_ne_u32 vcc, s47, v28
  v_cmp_ne_u32 s[94:95], s47, v29
  s_nop 0
  s_or_b64 vcc, vcc, s[94:95]
  v_cmp_ne_u32 s[94:95], s47, v30
  s_nop 0
  s_or_b64 vcc, vcc, s[94:95]
  v_cmp_ne_u32 s[94:95], s47, v31
  s_nop 0
  s_or_b64 vcc, vcc, s[94:95]
  s_cbranch_vccnz Lslow_16
Lback_17:
  v_mov_b32 v2, 0xb12000
  v_mov_b32 v3, s47
  s_mov_b64 s[88:89], exec
  s_mov_b64 exec, 1
  global_store_dword v2, v3, s[20:21] sc1
  s_mov_b64 exec, s[88:89]
Lnonce_15:
Lend:
  s_endpgm
Ltrole:
  s_sub_u32 s53, s46, 28
  s_lshl_b32 s53, s53, 3
  s_add_u32 s49, s53, s45
  v_lshlrev_b32 v20, 4, v1
  s_lshl_b32 s51, s49, 16
  s_lshl_b32 s53, s44, 14
  s_add_u32 s51, s51, s53
  s_mul_i32 s52, s44, 20480
  s_add_u32 m0, s52, 0
  s_add_u32 s59, s51, 0
  buffer_load_dwordx4 v20, s[8:11], s59 offen lds
  s_add_u32 m0, s52, 1312
  s_add_u32 s59, s51, 1024
  buffer_load_dwordx4 v20, s[8:11], s59 offen lds
  s_add_u32 m0, s52, 2624
  s_add_u32 s59, s51, 2048
  buffer_load_dwordx4 v20, s[8:11], s59 offen lds
  s_add_u32 m0, s52, 3936
  s_add_u32 s59, s51, 3072
  buffer_load_dwordx4 v20, s[8:11], s59 offen lds
  s_add_u32 m0, s52, 5120
  s_add_u32 s59, s51, 4096
  buffer_load_dwordx4 v20, s[8:11], s59 offen lds
  s_add_u32 m0, s52, 6432
  s_add_u32 s59, s51, 5120
  buffer_load_dwordx4 v20, s[8:11], s59 offen lds
  s_add_u32 m0, s52, 7744
  s_add_u32 s59, s51, 6144
  buffer_load_dwordx4 v20, s[8:11], s59 offen lds
  s_add_u32 m0, s52, 9056
  s_add_u32 s59, s51, 7168
  buffer_load_dwordx4 v20, s[8:11], s59 offen lds
  s_add_u32 m0, s52, 10368
  s_add_u32 s59, s51, 8192
  buffer_load_dwordx4 v20, s[8:11], s59 offen lds
  s_add_u32 m0, s52, 11680
  s_add_u32 s59, s51, 9216
  buffer_load_dwordx4 v20, s[8:11], s59 offen lds
  s_add_u32 m0, s52, 12992
  s_add_u32 s59, s51, 10240
  buffer_load_dwordx4 v20, s[8:11], s59 offen lds
  s_add_u32 m0, s52, 14304
  s_add_u32 s59, s51, 11264
  buffer_load_dwordx4 v20, s[8:11], s59 offen lds
  s_add_u32 m0, s52, 15488
  s_add_u32 s59, s51, 12288
  buffer_load_dwordx4 v20, s[8:11], s59 offen lds
  s_add_u32 m0, s52, 16800
  s_add_u32 s59, s51, 13312
  buffer_load_dwordx4 v20, s[8:11], s59 offen lds
  s_add_u32 m0, s52, 18112
  s_add_u32 s59, s51, 14336
  buffer_load_dwordx4 v20, s[8:11], s59 offen lds
  s_add_u32 m0, s52, 19424
  s_add_u32 s59, s51, 15360
  buffer_load_dwordx4 v20, s[8:11], s59 offen lds
  s_mov_b32 s12, s86
  s_mov_b32 s13, s87
  s_mov_b32 s14, 1024
  s_mov_b32 s15, 0x20000
  s_lshl_b32 s54, s44, 10
  s_add_u32 m0, s54, 90112
  s_mov_b32 s53, 0
  buffer_load_dwordx4 v20, s[12:15], s53 offen lds
  v_mov_b32 v8, 0xb12000
  global_load_dword v18, v8, s[20:21] sc1
  s_lshl_b32 s53, s45, 6
  s_lshl_b32 s54, s46, 1
  s_add_u32 s53, s53, s54
  s_add_u32 s3, s53, s57
  s_lshl_b32 s53, s3, 8
  s_lshl_b32 s54, s58, 7
  s_add_u32 s53, s53, s54
  v_lshlrev_b32 v9, 1, v1
  v_add_u32 v9, s53, v9
  global_load_ushort v10, v9, s[66:67]
  global_load_ushort v11, v9, s[68:69]
  global_load_ushort v12, v9, s[70:71]
  global_load_ushort v13, v9, s[72:73]
  global_load_ushort v14, v9, s[74:75]
  global_load_ushort v15, v9, s[76:77]
  s_lshl_b32 s53, s3, 1
  v_mov_b32 v8, s53
  global_load_ushort v16, v8, s[78:79]
  global_load_ushort v17, v8, s[42:43]
  s_getpc_b64 s[90:91]
Lpc_18:
  s_add_u32 s90, s90, Ltable-Lpc_18
  s_addc_u32 s91, s91, 0
  s_lshl_b32 s59, s58, 11
  v_lshlrev_b32 v9, 4, v1
  v_add_u32 v9, s59, v9
  global_load_dwordx4 v[224:227], v9, s[90:91]
  global_load_dwordx4 v[228:231], v9, s[90:91] offset:1024
  s_mov_b32 s60, 0x3fb8aa3b
  s_mov_b32 s61, 0x3fb8aa3b
  v_lshrrev_b32 v2, 3, v1
  v_and_b32 v3, 7, v1
  v_lshrrev_b32 v4, 4, v1
  v_and_b32 v4, 1, v4
  v_lshlrev_b32 v4, 2, v4
  v_xor_b32 v3, v3, v4
  v_lshlrev_b32 v3, 4, v3
  v_lshl_add_u32 v28, v2, 10, v3
  v_add_u32 v29, 7168, v28
  s_mul_i32 s92, s44, 458752
  s_and_b32 s53, s45, 1
  s_lshl_b32 s53, s53, 2
  s_and_b32 s54, s46, 3
  s_add_u32 s53, s53, s54
  s_lshl_b32 s53, s53, 7
  s_add_u32 s92, s92, s53
  s_lshl_b32 s93, s44, 13
  v_lshrrev_b32 v2, 5, v1
  v_lshrrev_b32 v3, 2, v1
  v_and_b32 v3, 3, v3
  v_lshl_add_u32 v2, v2, 2, v3
  v_lshlrev_b32 v2, 7, v2
  v_lshrrev_b32 v3, 1, v3
  v_lshl_add_u32 v2, v3, 6, v2
  v_lshrrev_b32 v3, 4, v1
  v_and_b32 v3, 1, v3
  v_lshl_add_u32 v2, v3, 5, v2
  v_and_b32 v3, 3, v1
  v_lshl_add_u32 v2, v3, 3, v2
  v_add_u32 v32, s93, v2
  v_xor_b32 v33, 64, v32
  v_add_u32 v30, 0x10000, v32
  v_add_u32 v31, 0x10000, v33
  v_and_b32 v2, 15, v1
  v_lshrrev_b32 v3, 4, v1
  v_mul_u32_u24 v4, 544, v2
  v_lshl_add_u32 v4, v3, 4, v4
  s_mul_i32 s53, s57, 28832
  s_add_u32 s53, s53, 98304
  v_add_u32 v233, s53, v4
  s_mul_i32 s54, s58, 8704
  v_add_u32 v232, s54, v233
  v_mov_b32 v234, 8
  v_mov_b32 v235, v2
  v_cmp_lt_u32 vcc, 7, v2
  v_add_u32 v6, 248, v2
  s_nop 0
  v_cndmask_b32 v234, v234, 4, vcc
  v_cndmask_b32 v235, v235, v6, vcc
  v_cmp_lt_u32 vcc, 11, v2
  v_add_u32 v6, 372, v2
  s_nop 0
  v_cndmask_b32 v234, v234, 2, vcc
  v_cndmask_b32 v235, v235, v6, vcc
  v_cmp_lt_u32 vcc, 13, v2
  v_add_u32 v6, 434, v2
  s_nop 0
  v_cndmask_b32 v235, v235, v6, vcc
  v_lshlrev_b32 v6, 5, v2
  v_add_u32 v237, 512, v6
  v_mov_b32 v236, 1
  v_cmp_lt_u32 vcc, 3, v2
  s_nop 1
  v_cndmask_b32 v236, v236, 8, vcc
  v_cmp_lt_u32 vcc, 4, v2
  v_mov_b32 v6, 700
  s_nop 0
  v_cndmask_b32 v237, v237, v6, vcc
  v_cndmask_b32 v236, v236, 0, vcc
  s_lshl_b32 s54, s58, 4
  v_lshlrev_b32 v6, 2, v3
  v_add_u32 v6, s54, v6
  s_lshl_b32 s53, s57, 11
  s_add_u32 s53, s53, 155972
  v_mad_u32_u24 v235, v234, v6, v235
  v_lshlrev_b32 v235, 1, v235
  v_add_u32 v235, s53, v235
  v_lshlrev_b32 v234, 1, v234
  v_mad_u32_u24 v237, v236, v6, v237
  v_lshlrev_b32 v237, 1, v237
  v_add_u32 v237, s53, v237
  v_lshlrev_b32 v236, 1, v236
  s_sub_u32 s53, s53, 4
  v_mov_b32 v239, s53
  v_sub_u32 v6, 577, v1
  v_lshrrev_b32 v6, 1, v6
  v_lshl_add_u32 v240, v6, 2, v239
  v_sub_u32 v6, 256, v1
  v_lshl_add_u32 v241, v6, 2, v239
  v_and_b32 v6, 1, v1
  v_cmp_eq_u32 vcc, 1, v6
  s_mov_b32 s67, 0x3020302
  s_mov_b32 s69, 0x1000100
  s_mov_b32 s53, 0x3020504
  s_cmp_eq_u32 s58, 0
  s_cselect_b32 s66, 0x5040504, s53
  s_cselect_b32 s68, 0x1000302, s69
  v_mov_b32 v6, s66
  v_mov_b32 v7, s68
  v_cndmask_b32 v243, v6, v7, vcc
  v_mov_b32 v6, 0x5040504
  v_mov_b32 v7, 0x3020302
  v_cndmask_b32 v242, v6, v7, vcc
  v_mov_b32 v6, 0x1000100
  v_cndmask_b32 v244, v7, v6, vcc
  s_lshl_b32 s54, s57, 1
  s_add_u32 s54, s54, s58
  s_mul_i32 s54, s54, 4160
  s_add_u32 s54, s54, 98304
  v_lshlrev_b32 v6, 4, v1
  v_add_u32 v238, s54, v6
  v_min_u32 v6, 1, v1
  v_lshlrev_b32 v6, 4, v6
  v_add_u32 v245, s54, v6
  v_lshrrev_b32 v2, 4, v1
  v_lshrrev_b32 v3, 2, v1
  v_and_b32 v3, 3, v3
  v_lshl_add_u32 v4, v2, 3, v3
  v_mul_u32_u24 v4, 1280, v4
  v_and_b32 v6, 1, v2
  v_lshl_add_u32 v6, v6, 2, v3
  v_lshl_add_u32 v4, v6, 5, v4
  v_and_b32 v6, 3, v1
  v_lshl_add_u32 v4, v6, 3, v4
  s_lshl_b32 s53, s44, 8
  v_add_u32 v21, s53, v4
  s_lshl_b32 s53, s44, 19
  s_lshl_b32 s54, s49, 11
  s_add_u32 s53, s53, s54
  v_lshlrev_b32 v22, 4, v1
  v_add_u32 v22, s53, v22
  v_and_b32 v4, 15, v1
  v_mul_u32_u24 v5, 1280, v4
  v_and_b32 v6, 3, v4
  v_lshrrev_b32 v7, 3, v4
  v_lshl_add_u32 v6, v7, 2, v6
  v_lshl_add_u32 v5, v6, 5, v5
  v_lshrrev_b32 v2, 4, v1
  v_lshl_add_u32 v5, v2, 4, v5
  v_add_u32 v5, s52, v5
  v_lshlrev_b32 v3, 4, v2
  s_lshl_b32 s54, s44, 10
  s_add_u32 s54, s54, 90112
  v_add_u32 v3, s54, v3
  s_waitcnt vmcnt(11)
  s_barrier
  ds_read_b64_tr_b16 v[64:65], v21 offset:0
  ds_read_b64_tr_b16 v[66:67], v21 offset:5120
  ds_read_b64_tr_b16 v[68:69], v21 offset:40960
  ds_read_b64_tr_b16 v[70:71], v21 offset:46080
  ds_read_b64_tr_b16 v[72:73], v21 offset:32
  ds_read_b64_tr_b16 v[74:75], v21 offset:5152
  ds_read_b64_tr_b16 v[76:77], v21 offset:40992
  ds_read_b64_tr_b16 v[78:79], v21 offset:46112
  ds_read_b64_tr_b16 v[80:81], v21 offset:64
  ds_read_b64_tr_b16 v[82:83], v21 offset:5184
  ds_read_b64_tr_b16 v[84:85], v21 offset:41024
  ds_read_b64_tr_b16 v[86:87], v21 offset:46144
  ds_read_b64_tr_b16 v[88:89], v21 offset:96
  ds_read_b64_tr_b16 v[90:91], v21 offset:5216
  ds_read_b64_tr_b16 v[92:93], v21 offset:41056
  ds_read_b64_tr_b16 v[94:95], v21 offset:46176
  ds_read_b64_tr_b16 v[96:97], v21 offset:128
  ds_read_b64_tr_b16 v[98:99], v21 offset:5248
  ds_read_b64_tr_b16 v[100:101], v21 offset:41088
  ds_read_b64_tr_b16 v[102:103], v21 offset:46208
  ds_read_b64_tr_b16 v[104:105], v21 offset:160
  ds_read_b64_tr_b16 v[106:107], v21 offset:5280
  ds_read_b64_tr_b16 v[108:109], v21 offset:41120
  ds_read_b64_tr_b16 v[110:111], v21 offset:46240
  ds_read_b64_tr_b16 v[112:113], v21 offset:192
  ds_read_b64_tr_b16 v[114:115], v21 offset:5312
  ds_read_b64_tr_b16 v[116:117], v21 offset:41152
  ds_read_b64_tr_b16 v[118:119], v21 offset:46272
  ds_read_b64_tr_b16 v[120:121], v21 offset:224
  ds_read_b64_tr_b16 v[122:123], v21 offset:5344
  ds_read_b64_tr_b16 v[124:125], v21 offset:41184
  ds_read_b64_tr_b16 v[126:127], v21 offset:46304
  ds_read_b128 v[176:179], v5 offset:0
  ds_read_b128 v[144:147], v3 offset:0
  ds_read_b128 v[180:183], v5 offset:64
  ds_read_b128 v[148:151], v3 offset:64
  ds_read_b128 v[184:187], v5 offset:128
  ds_read_b128 v[152:155], v3 offset:128
  ds_read_b128 v[188:191], v5 offset:192
  ds_read_b128 v[156:159], v3 offset:192
  s_waitcnt lgkmcnt(15)
  global_store_dwordx4 v22, v[64:67], s[20:21] offset:0 sc1
  s_waitcnt lgkmcnt(6)
  v_mfma_f32_16x16x32_bf16 v[24:27], v[144:147], v[176:179], 0
  ds_read_b128 v[192:195], v5 offset:256
  ds_read_b128 v[160:163], v3 offset:256
  global_store_dwordx4 v22, v[68:71], s[20:21] offset:1024 sc1
  s_waitcnt lgkmcnt(6)
  v_mfma_f32_16x16x32_bf16 v[24:27], v[148:151], v[180:183], v[24:27]
  ds_read_b128 v[196:199], v5 offset:320
  ds_read_b128 v[164:167], v3 offset:320
  v_add_u32 v22, 0x10000, v22
  global_store_dwordx4 v22, v[72:75], s[20:21] offset:0 sc1
  s_waitcnt lgkmcnt(6)
  v_mfma_f32_16x16x32_bf16 v[24:27], v[152:155], v[184:187], v[24:27]
  ds_read_b128 v[200:203], v5 offset:384
  ds_read_b128 v[168:171], v3 offset:384
  global_store_dwordx4 v22, v[76:79], s[20:21] offset:1024 sc1
  s_waitcnt lgkmcnt(6)
  v_mfma_f32_16x16x32_bf16 v[24:27], v[156:159], v[188:191], v[24:27]
  ds_read_b128 v[204:207], v5 offset:448
  ds_read_b128 v[172:175], v3 offset:448
  v_add_u32 v22, 0x10000, v22
  global_store_dwordx4 v22, v[80:83], s[20:21] offset:0 sc1
  s_waitcnt lgkmcnt(6)
  v_mfma_f32_16x16x32_bf16 v[24:27], v[160:163], v[192:195], v[24:27]
  ds_read_b128 v[176:179], v5 offset:512
  ds_read_b128 v[144:147], v3 offset:512
  global_store_dwordx4 v22, v[84:87], s[20:21] offset:1024 sc1
  s_waitcnt lgkmcnt(6)
  v_mfma_f32_16x16x32_bf16 v[24:27], v[164:167], v[196:199], v[24:27]
  ds_read_b128 v[180:183], v5 offset:576
  ds_read_b128 v[148:151], v3 offset:576
  v_add_u32 v22, 0x10000, v22
  global_store_dwordx4 v22, v[88:91], s[20:21] offset:0 sc1
  s_waitcnt lgkmcnt(6)
  v_mfma_f32_16x16x32_bf16 v[24:27], v[168:171], v[200:203], v[24:27]
  ds_read_b128 v[184:187], v5 offset:640
  ds_read_b128 v[152:155], v3 offset:640
  global_store_dwordx4 v22, v[92:95], s[20:21] offset:1024 sc1
  s_waitcnt lgkmcnt(6)
  v_mfma_f32_16x16x32_bf16 v[24:27], v[172:175], v[204:207], v[24:27]
  ds_read_b128 v[188:191], v5 offset:704
  ds_read_b128 v[156:159], v3 offset:704
  v_add_u32 v22, 0x10000, v22
  global_store_dwordx4 v22, v[96:99], s[20:21] offset:0 sc1
  s_waitcnt lgkmcnt(6)
  v_mfma_f32_16x16x32_bf16 v[24:27], v[144:147], v[176:179], v[24:27]
  ds_read_b128 v[192:195], v5 offset:768
  ds_read_b128 v[160:163], v3 offset:768
  global_store_dwordx4 v22, v[100:103], s[20:21] offset:1024 sc1
  s_waitcnt lgkmcnt(6)
  v_mfma_f32_16x16x32_bf16 v[24:27], v[148:151], v[180:183], v[24:27]
  ds_read_b128 v[196:199], v5 offset:832
  ds_read_b128 v[164:167], v3 offset:832
  v_add_u32 v22, 0x10000, v22
  global_store_dwordx4 v22, v[104:107], s[20:21] offset:0 sc1
  s_waitcnt lgkmcnt(6)
  v_mfma_f32_16x16x32_bf16 v[24:27], v[152:155], v[184:187], v[24:27]
  ds_read_b128 v[200:203], v5 offset:896
  ds_read_b128 v[168:171], v3 offset:896
  global_store_dwordx4 v22, v[108:111], s[20:21] offset:1024 sc1
  s_waitcnt lgkmcnt(6)
  v_mfma_f32_16x16x32_bf16 v[24:27], v[156:159], v[188:191], v[24:27]
  ds_read_b128 v[204:207], v5 offset:960
  ds_read_b128 v[172:175], v3 offset:960
  v_add_u32 v22, 0x10000, v22
  global_store_dwordx4 v22, v[112:115], s[20:21] offset:0 sc1
  s_waitcnt lgkmcnt(6)
  v_mfma_f32_16x16x32_bf16 v[24:27], v[160:163], v[192:195], v[24:27]
  global_store_dwordx4 v22, v[116:119], s[20:21] offset:1024 sc1
  s_waitcnt lgkmcnt(4)
  v_mfma_f32_16x16x32_bf16 v[24:27], v[164:167], v[196:199], v[24:27]
  v_add_u32 v22, 0x10000, v22
  global_store_dwordx4 v22, v[120:123], s[20:21] offset:0 sc1
  s_waitcnt lgkmcnt(2)
  v_mfma_f32_16x16x32_bf16 v[24:27], v[168:171], v[200:203], v[24:27]
  global_store_dwordx4 v22, v[124:127], s[20:21] offset:1024 sc1
  s_waitcnt lgkmcnt(0)
  v_mfma_f32_16x16x32_bf16 v[24:27], v[172:175], v[204:207], v[24:27]
  s_lshl_b32 s53, s49, 8
  s_lshl_b32 s54, s44, 6
  s_add_u32 s53, s53, s54
  s_add_u32 s53, s53, 0xb00000
  v_lshlrev_b32 v6, 2, v1
  v_add_u32 v6, s53, v6
  s_nop 1
  v_mul_f32 v24, 0xbfb8aa3b, v24
  v_exp_f32 v24, v24
  s_nop 0
  v_add_f32 v24, 1.0, v24
  v_rcp_f32 v24, v24
  s_mov_b64 s[88:89], exec
  s_mov_b64 exec, 0xffff
  global_store_dword v6, v24, s[20:21] sc1
  s_mov_b64 exec, s[88:89]
  s_waitcnt vmcnt(27)
  v_readfirstlane_b32 s47, v18
  s_nop 1
  s_mul_i32 s47, s47, 0x9E3779B1
  s_add_u32 s47, s47, 0x7F4A7C15
  s_or_b32 s47, s47, 1
  s_lshl_b32 s53, s49, 2
  s_add_u32 s53, s53, 0xb10000
  s_waitcnt vmcnt(0)
  s_waitcnt lgkmcnt(0)
  s_barrier
  s_cmp_lg_u32 s44, 0
  s_cbranch_scc1 Lnoflag_19
  v_mov_b32 v62, s53
  v_mov_b32 v63, s47
  s_mov_b64 s[88:89], exec
  s_mov_b64 exec, 1
  global_store_dword v62, v63, s[20:21] sc1
  s_mov_b64 exec, s[88:89]
Lnoflag_19:
  s_lshl_b32 s53, s49, 2
  s_add_u32 s53, s53, s44
  s_mul_i32 s53, s53, 14336
  v_lshlrev_b32 v2, 7, v1
  v_add_u32 v2, s53, v2
  global_load_dword v59, v2, s[84:85]
  v_min_u32 v2, 47, v1
  v_lshlrev_b32 v2, 7, v2
  v_add_u32 v2, s53, v2
  v_add_u32 v2, 8192, v2
  global_load_dword v59, v2, s[84:85]
  v_min_u32 v61, 31, v1
  v_lshlrev_b32 v61, 2, v61
  v_add_u32 v61, 0xb10000, v61
  global_load_dword v60, v61, s[20:21] sc1
  v_lshlrev_b32 v10, 16, v10
  v_lshlrev_b32 v11, 16, v11
  v_lshlrev_b32 v12, 16, v12
  v_lshlrev_b32 v13, 16, v13
  v_lshlrev_b32 v14, 16, v14
  v_lshlrev_b32 v15, 16, v15
  v_lshlrev_b32 v16, 16, v16
  v_lshlrev_b32 v17, 16, v17
  v_mul_f32 v2, s60, v16
  v_mov_b32 v4, 0x32a57060
  v_fma_f32 v3, v16, s60, -v2
  v_exp_f32 v2, v2
  v_fmac_f32 v3, v16, v4
  v_mul_f32 v3, 0x3f317218, v3
  v_fma_f32 v2, v2, v3, v2
  v_cvt_pk_bf16_f32 v2, v2, v2
  v_lshlrev_b32 v2, 16, v2
  v_mul_f32 v10, v2, v10
  v_mul_f32 v11, v2, v11
  v_mul_f32 v12, v2, v12
  v_mul_f32 v13, v2, v13
  v_mul_f32 v10, s60, v10
  v_mul_f32 v11, 0x3e22f983, v11
  v_mul_f32 v64, v14, v12
  v_mul_f32 v65, v14, v13
  v_fma_f32 v64, -v15, v13, v64
  v_fma_f32 v65, v15, v12, v65
  v_mul_f32 v3, 0x41000000, v11
  v_mul_f32 v2, 0x41000000, v10
  v_mul_f32 v113, 0x3f800000, v11
  v_mul_f32 v112, 0x3f800000, v10
  v_mul_f32 v117, 0x43800000, v11
  v_mul_f32 v116, 0x43800000, v10
  v_fract_f32 v3, v3
  v_exp_f32 v2, v2
  v_fract_f32 v113, v113
  v_exp_f32 v112, v112
  v_fract_f32 v117, v117
  v_exp_f32 v116, v116
  v_cos_f32 v4, v3
  v_sin_f32 v5, v3
  v_cos_f32 v114, v113
  v_sin_f32 v115, v113
  v_cos_f32 v118, v117
  v_sin_f32 v119, v117
  v_mul_f32 v68, v2, v4
  v_mul_f32 v69, v2, v5
  v_mul_f32 v66, v112, v114
  v_mul_f32 v67, v112, v115
  v_mul_f32 v70, v116, v118
  v_mul_f32 v71, v116, v119
  s_add_u32 m0, s93, 65536
  s_add_u32 s59, s92, 0
  buffer_load_dwordx4 v28, s[16:19], s59 offen lds
  s_mul_i32 s53, s57, 28832
  s_lshl_b32 s54, s58, 8
  s_add_u32 s53, s53, s54
  s_add_u32 s53, s53, 98304
  v_lshlrev_b32 v6, 2, v1
  v_add_u32 v6, s53, v6
  v_pk_mul_f32 v[72:73], v[68:69], v[68:69] op_sel:[0,0] op_sel_hi:[0,1]
  v_pk_mul_f32 v[74:75], v[64:65], v[68:69] op_sel:[0,0] op_sel_hi:[0,1]
  v_mov_b32 v86, v64
  v_mov_b32 v87, v65
  v_pk_fma_f32 v[84:85], v[68:69], v[68:69], v[72:73] op_sel:[1,1,0] op_sel_hi:[1,0,1] neg_lo:[0,1,0]
  v_pk_fma_f32 v[90:91], v[64:65], v[68:69], v[74:75] op_sel:[1,1,0] op_sel_hi:[1,0,1] neg_lo:[0,1,0]
  v_mov_b32 v7, 0x3f80
  v_cvt_pk_bf16_f32 v80, v66, -v67
  v_cvt_pk_bf16_f32 v81, v70, -v71
  ds_write_b32 v6, v7 offset:17408
  ds_write_b32 v6, v80 offset:17952
  ds_write_b32 v6, v81 offset:21760
  v_pk_mul_f32 v[72:73], v[86:87], v[84:85] op_sel:[0,0] op_sel_hi:[0,1]
  v_pk_mul_f32 v[74:75], v[90:91], v[84:85] op_sel:[0,0] op_sel_hi:[0,1]
  v_pk_mul_f32 v[76:77], v[66:67], v[66:67] op_sel:[0,0] op_sel_hi:[0,1]
  v_pk_mul_f32 v[78:79], v[70:71], v[70:71] op_sel:[0,0] op_sel_hi:[0,1]
  v_cvt_pk_bf16_f32 v82, v86, v87
  v_cvt_pk_bf16_f32 v83, v90, v91
  v_pk_fma_f32 v[88:89], v[86:87], v[84:85], v[72:73] op_sel:[1,1,0] op_sel_hi:[1,0,1] neg_lo:[0,1,0]
  v_pk_fma_f32 v[92:93], v[90:91], v[84:85], v[74:75] op_sel:[1,1,0] op_sel_hi:[1,0,1] neg_lo:[0,1,0]
  v_pk_fma_f32 v[94:95], v[66:67], v[66:67], v[76:77] op_sel:[1,1,0] op_sel_hi:[1,0,1] neg_lo:[0,1,0]
  v_pk_fma_f32 v[106:107], v[70:71], v[70:71], v[78:79] op_sel:[1,1,0] op_sel_hi:[1,0,1] neg_lo:[0,1,0]
  buffer_load_dwordx4 v29, s[16:19], s59 offen offset:1024 lds
  v_pk_mul_f32 v[72:73], v[88:89], v[84:85] op_sel:[0,0] op_sel_hi:[0,1]
  v_pk_mul_f32 v[74:75], v[92:93], v[84:85] op_sel:[0,0] op_sel_hi:[0,1]
  v_pk_mul_f32 v[76:77], v[94:95], v[66:67] op_sel:[0,0] op_sel_hi:[0,1]
  v_pk_mul_f32 v[78:79], v[94:95], v[94:95] op_sel:[0,0] op_sel_hi:[0,1]
  v_cvt_pk_bf16_f32 v120, v88, v89
  v_cvt_pk_bf16_f32 v121, v92, v93
  ds_write_b32 v6, v82 offset:0
  v_cvt_pk_bf16_f32 v122, v94, -v95
  v_cvt_pk_bf16_f32 v123, v106, -v107
  v_pk_fma_f32 v[86:87], v[88:89], v[84:85], v[72:73] op_sel:[1,1,0] op_sel_hi:[1,0,1] neg_lo:[0,1,0]
  v_pk_fma_f32 v[90:91], v[92:93], v[84:85], v[74:75] op_sel:[1,1,0] op_sel_hi:[1,0,1] neg_lo:[0,1,0]
  v_pk_fma_f32 v[96:97], v[94:95], v[66:67], v[76:77] op_sel:[1,1,0] op_sel_hi:[1,0,1] neg_lo:[0,1,0]
  v_pk_fma_f32 v[98:99], v[94:95], v[94:95], v[78:79] op_sel:[1,1,0] op_sel_hi:[1,0,1] neg_lo:[0,1,0]
  ds_write_b32 v6, v83 offset:544
  s_add_u32 m0, s93, 67584
  s_add_u32 s59, s92, 16384
  buffer_load_dwordx4 v28, s[16:19], s59 offen lds
  v_pk_mul_f32 v[72:73], v[86:87], v[84:85] op_sel:[0,0] op_sel_hi:[0,1]
  v_pk_mul_f32 v[74:75], v[90:91], v[84:85] op_sel:[0,0] op_sel_hi:[0,1]
  ds_write_b32 v6, v120 offset:1088
  v_pk_mul_f32 v[76:77], v[106:107], v[70:71] op_sel:[0,0] op_sel_hi:[0,1]
  v_cvt_pk_bf16_f32 v80, v86, v87
  ds_write_b32 v6, v121 offset:1632
  v_cvt_pk_bf16_f32 v81, v90, v91
  v_cvt_pk_bf16_f32 v82, v96, -v97
  ds_write_b32 v6, v122 offset:18496
  v_cvt_pk_bf16_f32 v83, v98, -v99
  v_pk_fma_f32 v[88:89], v[86:87], v[84:85], v[72:73] op_sel:[1,1,0] op_sel_hi:[1,0,1] neg_lo:[0,1,0]
  ds_write_b32 v6, v123 offset:23936
  v_pk_fma_f32 v[92:93], v[90:91], v[84:85], v[74:75] op_sel:[1,1,0] op_sel_hi:[1,0,1] neg_lo:[0,1,0]
  v_pk_fma_f32 v[108:109], v[106:107], v[70:71], v[76:77] op_sel:[1,1,0] op_sel_hi:[1,0,1] neg_lo:[0,1,0]
  buffer_load_dwordx4 v29, s[16:19], s59 offen offset:1024 lds
  v_pk_mul_f32 v[72:73], v[88:89], v[84:85] op_sel:[0,0] op_sel_hi:[0,1]
  v_pk_mul_f32 v[74:75], v[92:93], v[84:85] op_sel:[0,0] op_sel_hi:[0,1]
  ds_write_b32 v6, v80 offset:2176
  v_pk_mul_f32 v[76:77], v[98:99], v[66:67] op_sel:[0,0] op_sel_hi:[0,1]
  v_cvt_pk_bf16_f32 v120, v88, v89
  ds_write_b32 v6, v81 offset:2720
  v_cvt_pk_bf16_f32 v121, v92, v93
  v_cvt_pk_bf16_f32 v122, v108, -v109
  ds_write_b32 v6, v82 offset:19040
  v_pk_fma_f32 v[86:87], v[88:89], v[84:85], v[72:73] op_sel:[1,1,0] op_sel_hi:[1,0,1] neg_lo:[0,1,0]
  v_pk_fma_f32 v[90:91], v[92:93], v[84:85], v[74:75] op_sel:[1,1,0] op_sel_hi:[1,0,1] neg_lo:[0,1,0]
  ds_write_b32 v6, v83 offset:19584
  v_pk_fma_f32 v[100:101], v[98:99], v[66:67], v[76:77] op_sel:[1,1,0] op_sel_hi:[1,0,1] neg_lo:[0,1,0]
  s_add_u32 m0, s93, 69632
  s_add_u32 s59, s92, 32768
  buffer_load_dwordx4 v28, s[16:19], s59 offen lds
  v_pk_mul_f32 v[72:73], v[86:87], v[84:85] op_sel:[0,0] op_sel_hi:[0,1]
  v_pk_mul_f32 v[74:75], v[90:91], v[84:85] op_sel:[0,0] op_sel_hi:[0,1]
  v_pk_mul_f32 v[76:77], v[98:99], v[94:95] op_sel:[0,0] op_sel_hi:[0,1]
  ds_write_b32 v6, v120 offset:3264
  v_cvt_pk_bf16_f32 v123, v86, v87
  v_cvt_pk_bf16_f32 v80, v90, v91
  v_cvt_pk_bf16_f32 v81, v100, -v101
  ds_write_b32 v6, v121 offset:3808
  v_pk_fma_f32 v[88:89], v[86:87], v[84:85], v[72:73] op_sel:[1,1,0] op_sel_hi:[1,0,1] neg_lo:[0,1,0]
  v_pk_fma_f32 v[92:93], v[90:91], v[84:85], v[74:75] op_sel:[1,1,0] op_sel_hi:[1,0,1] neg_lo:[0,1,0]
  v_pk_fma_f32 v[102:103], v[98:99], v[94:95], v[76:77] op_sel:[1,1,0] op_sel_hi:[1,0,1] neg_lo:[0,1,0]
  ds_write_b32 v6, v122 offset:25024
  v_pk_mul_f32 v[72:73], v[88:89], v[84:85] op_sel:[0,0] op_sel_hi:[0,1]
  v_pk_mul_f32 v[74:75], v[92:93], v[84:85] op_sel:[0,0] op_sel_hi:[0,1]
  v_pk_mul_f32 v[76:77], v[106:107], v[106:107] op_sel:[0,0] op_sel_hi:[0,1]
  ds_write_b32 v6, v123 offset:4352
  v_cvt_pk_bf16_f32 v82, v88, v89
  v_cvt_pk_bf16_f32 v83, v92, v93
  v_cvt_pk_bf16_f32 v120, v102, -v103
  ds_write_b32 v6, v80 offset:4896
  v_pk_fma_f32 v[86:87], v[88:89], v[84:85], v[72:73] op_sel:[1,1,0] op_sel_hi:[1,0,1] neg_lo:[0,1,0]
  v_pk_fma_f32 v[90:91], v[92:93], v[84:85], v[74:75] op_sel:[1,1,0] op_sel_hi:[1,0,1] neg_lo:[0,1,0]
  v_pk_fma_f32 v[110:111], v[106:107], v[106:107], v[76:77] op_sel:[1,1,0] op_sel_hi:[1,0,1] neg_lo:[0,1,0]
  ds_write_b32 v6, v81 offset:20128
  buffer_load_dwordx4 v29, s[16:19], s59 offen offset:1024 lds
  v_pk_mul_f32 v[72:73], v[86:87], v[84:85] op_sel:[0,0] op_sel_hi:[0,1]
  v_pk_mul_f32 v[74:75], v[90:91], v[84:85] op_sel:[0,0] op_sel_hi:[0,1]
  v_pk_mul_f32 v[76:77], v[98:99], v[96:97] op_sel:[0,0] op_sel_hi:[0,1]
  ds_write_b32 v6, v82 offset:5440
  v_cvt_pk_bf16_f32 v121, v86, v87
  v_cvt_pk_bf16_f32 v122, v90, v91
  v_cvt_pk_bf16_f32 v123, v110, -v111
  ds_write_b32 v6, v83 offset:5984
  v_pk_fma_f32 v[88:89], v[86:87], v[84:85], v[72:73] op_sel:[1,1,0] op_sel_hi:[1,0,1] neg_lo:[0,1,0]
  v_pk_fma_f32 v[92:93], v[90:91], v[84:85], v[74:75] op_sel:[1,1,0] op_sel_hi:[1,0,1] neg_lo:[0,1,0]
  v_pk_fma_f32 v[104:105], v[98:99], v[96:97], v[76:77] op_sel:[1,1,0] op_sel_hi:[1,0,1] neg_lo:[0,1,0]
  ds_write_b32 v6, v120 offset:20672
  v_pk_mul_f32 v[72:73], v[88:89], v[84:85] op_sel:[0,0] op_sel_hi:[0,1]
  v_pk_mul_f32 v[74:75], v[92:93], v[84:85] op_sel:[0,0] op_sel_hi:[0,1]
  v_pk_mul_f32 v[76:77], v[70:71], v[94:95] op_sel:[0,0] op_sel_hi:[0,1]
  ds_write_b32 v6, v121 offset:6528
  v_cvt_pk_bf16_f32 v80, v88, v89
  v_cvt_pk_bf16_f32 v81, v92, v93
  v_cvt_pk_bf16_f32 v82, v104, -v105
  ds_write_b32 v6, v122 offset:7072
  v_pk_fma_f32 v[86:87], v[88:89], v[84:85], v[72:73] op_sel:[1,1,0] op_sel_hi:[1,0,1] neg_lo:[0,1,0]
  v_pk_fma_f32 v[90:91], v[92:93], v[84:85], v[74:75] op_sel:[1,1,0] op_sel_hi:[1,0,1] neg_lo:[0,1,0]
  v_pk_fma_f32 v[112:113], v[70:71], v[94:95], v[76:77] op_sel:[1,1,0] op_sel_hi:[1,0,1] neg_lo:[0,1,0]
  ds_write_b32 v6, v123 offset:26112
  s_add_u32 m0, s93, 71680
  s_add_u32 s59, s92, 49152
  buffer_load_dwordx4 v28, s[16:19], s59 offen lds
  v_pk_mul_f32 v[72:73], v[86:87], v[84:85] op_sel:[0,0] op_sel_hi:[0,1]
  v_pk_mul_f32 v[74:75], v[90:91], v[84:85] op_sel:[0,0] op_sel_hi:[0,1]
  v_pk_mul_f32 v[76:77], v[70:71], v[98:99] op_sel:[0,0] op_sel_hi:[0,1]
  ds_write_b32 v6, v80 offset:7616
  v_cvt_pk_bf16_f32 v83, v86, v87
  v_cvt_pk_bf16_f32 v120, v90, v91
  v_cvt_pk_bf16_f32 v121, v112, -v113
  ds_write_b32 v6, v81 offset:8160
  v_pk_fma_f32 v[88:89], v[86:87], v[84:85], v[72:73] op_sel:[1,1,0] op_sel_hi:[1,0,1] neg_lo:[0,1,0]
  v_pk_fma_f32 v[92:93], v[90:91], v[84:85], v[74:75] op_sel:[1,1,0] op_sel_hi:[1,0,1] neg_lo:[0,1,0]
  v_pk_fma_f32 v[114:115], v[70:71], v[98:99], v[76:77] op_sel:[1,1,0] op_sel_hi:[1,0,1] neg_lo:[0,1,0]
  ds_write_b32 v6, v82 offset:21216
  v_pk_mul_f32 v[72:73], v[88:89], v[84:85] op_sel:[0,0] op_sel_hi:[0,1]
  v_pk_mul_f32 v[74:75], v[92:93], v[84:85] op_sel:[0,0] op_sel_hi:[0,1]
  v_pk_mul_f32 v[76:77], v[70:71], v[102:103] op_sel:[0,0] op_sel_hi:[0,1]
  ds_write_b32 v6, v83 offset:8704
  v_cvt_pk_bf16_f32 v122, v88, v89
  v_cvt_pk_bf16_f32 v123, v92, v93
  v_cvt_pk_bf16_f32 v80, v114, -v115
  ds_write_b32 v6, v120 offset:9248
  v_pk_fma_f32 v[86:87], v[88:89], v[84:85], v[72:73] op_sel:[1,1,0] op_sel_hi:[1,0,1] neg_lo:[0,1,0]
  v_pk_fma_f32 v[90:91], v[92:93], v[84:85], v[74:75] op_sel:[1,1,0] op_sel_hi:[1,0,1] neg_lo:[0,1,0]
  v_pk_fma_f32 v[112:113], v[70:71], v[102:103], v[76:77] op_sel:[1,1,0] op_sel_hi:[1,0,1] neg_lo:[0,1,0]
  ds_write_b32 v6, v121 offset:22304
  buffer_load_dwordx4 v29, s[16:19], s59 offen offset:1024 lds
  v_pk_mul_f32 v[72:73], v[86:87], v[84:85] op_sel:[0,0] op_sel_hi:[0,1]
  v_pk_mul_f32 v[74:75], v[90:91], v[84:85] op_sel:[0,0] op_sel_hi:[0,1]
  v_pk_mul_f32 v[76:77], v[106:107], v[98:99] op_sel:[0,0] op_sel_hi:[0,1]
  ds_write_b32 v6, v122 offset:9792
  v_cvt_pk_bf16_f32 v81, v86, v87
  v_cvt_pk_bf16_f32 v82, v90, v91
  v_cvt_pk_bf16_f32 v83, v112, -v113
  ds_write_b32 v6, v123 offset:10336
  v_pk_fma_f32 v[88:89], v[86:87], v[84:85], v[72:73] op_sel:[1,1,0] op_sel_hi:[1,0,1] neg_lo:[0,1,0]
  v_pk_fma_f32 v[92:93], v[90:91], v[84:85], v[74:75] op_sel:[1,1,0] op_sel_hi:[1,0,1] neg_lo:[0,1,0]
  v_pk_fma_f32 v[114:115], v[106:107], v[98:99], v[76:77] op_sel:[1,1,0] op_sel_hi:[1,0,1] neg_lo:[0,1,0]
  ds_write_b32 v6, v80 offset:22848
  v_pk_mul_f32 v[72:73], v[88:89], v[84:85] op_sel:[0,0] op_sel_hi:[0,1]
  v_pk_mul_f32 v[74:75], v[92:93], v[84:85] op_sel:[0,0] op_sel_hi:[0,1]
  v_pk_mul_f32 v[76:77], v[108:109], v[98:99] op_sel:[0,0] op_sel_hi:[0,1]
  ds_write_b32 v6, v81 offset:10880
  v_cvt_pk_bf16_f32 v120, v88, v89
  v_cvt_pk_bf16_f32 v121, v92, v93
  v_cvt_pk_bf16_f32 v122, v114, -v115
  ds_write_b32 v6, v82 offset:11424
  v_pk_fma_f32 v[86:87], v[88:89], v[84:85], v[72:73] op_sel:[1,1,0] op_sel_hi:[1,0,1] neg_lo:[0,1,0]
  v_pk_fma_f32 v[90:91], v[92:93], v[84:85], v[74:75] op_sel:[1,1,0] op_sel_hi:[1,0,1] neg_lo:[0,1,0]
  v_pk_fma_f32 v[112:113], v[108:109], v[98:99], v[76:77] op_sel:[1,1,0] op_sel_hi:[1,0,1] neg_lo:[0,1,0]
  ds_write_b32 v6, v83 offset:23392
  v_pk_mul_f32 v[72:73], v[86:87], v[84:85] op_sel:[0,0] op_sel_hi:[0,1]
  v_pk_mul_f32 v[74:75], v[90:91], v[84:85] op_sel:[0,0] op_sel_hi:[0,1]
  v_pk_mul_f32 v[76:77], v[110:111], v[70:71] op_sel:[0,0] op_sel_hi:[0,1]
  ds_write_b32 v6, v120 offset:11968
  v_cvt_pk_bf16_f32 v123, v86, v87
  v_cvt_pk_bf16_f32 v80, v90, v91
  v_cvt_pk_bf16_f32 v81, v112, -v113
  ds_write_b32 v6, v121 offset:12512
  v_pk_fma_f32 v[88:89], v[86:87], v[84:85], v[72:73] op_sel:[1,1,0] op_sel_hi:[1,0,1] neg_lo:[0,1,0]
  v_pk_fma_f32 v[92:93], v[90:91], v[84:85], v[74:75] op_sel:[1,1,0] op_sel_hi:[1,0,1] neg_lo:[0,1,0]
  v_pk_fma_f32 v[114:115], v[110:111], v[70:71], v[76:77] op_sel:[1,1,0] op_sel_hi:[1,0,1] neg_lo:[0,1,0]
  ds_write_b32 v6, v122 offset:24480
  v_pk_mul_f32 v[72:73], v[88:89], v[84:85] op_sel:[0,0] op_sel_hi:[0,1]
  v_pk_mul_f32 v[74:75], v[92:93], v[84:85] op_sel:[0,0] op_sel_hi:[0,1]
  v_pk_mul_f32 v[76:77], v[110:111], v[106:107] op_sel:[0,0] op_sel_hi:[0,1]
  ds_write_b32 v6, v123 offset:13056
  v_cvt_pk_bf16_f32 v82, v88, v89
  v_cvt_pk_bf16_f32 v83, v92, v93
  v_cvt_pk_bf16_f32 v120, v114, -v115
  ds_write_b32 v6, v80 offset:13600
  v_pk_fma_f32 v[86:87], v[88:89], v[84:85], v[72:73] op_sel:[1,1,0] op_sel_hi:[1,0,1] neg_lo:[0,1,0]
  v_pk_fma_f32 v[90:91], v[92:93], v[84:85], v[74:75] op_sel:[1,1,0] op_sel_hi:[1,0,1] neg_lo:[0,1,0]
  v_pk_fma_f32 v[112:113], v[110:111], v[106:107], v[76:77] op_sel:[1,1,0] op_sel_hi:[1,0,1] neg_lo:[0,1,0]
  ds_write_b32 v6, v81 offset:25568
  s_add_u32 m0, s93, 0
  s_add_u32 s59, s92, 65536
  buffer_load_dwordx4 v28, s[16:19], s59 offen lds
  v_pk_mul_f32 v[72:73], v[86:87], v[84:85] op_sel:[0,0] op_sel_hi:[0,1]
  v_pk_mul_f32 v[74:75], v[90:91], v[84:85] op_sel:[0,0] op_sel_hi:[0,1]
  v_pk_mul_f32 v[76:77], v[110:111], v[108:109] op_sel:[0,0] op_sel_hi:[0,1]
  ds_write_b32 v6, v82 offset:14144
  v_cvt_pk_bf16_f32 v121, v86, v87
  v_cvt_pk_bf16_f32 v122, v90, v91
  v_cvt_pk_bf16_f32 v123, v112, -v113
  ds_write_b32 v6, v83 offset:14688
  v_pk_fma_f32 v[88:89], v[86:87], v[84:85], v[72:73] op_sel:[1,1,0] op_sel_hi:[1,0,1] neg_lo:[0,1,0]
  v_pk_fma_f32 v[92:93], v[90:91], v[84:85], v[74:75] op_sel:[1,1,0] op_sel_hi:[1,0,1] neg_lo:[0,1,0]
  v_pk_fma_f32 v[114:115], v[110:111], v[108:109], v[76:77] op_sel:[1,1,0] op_sel_hi:[1,0,1] neg_lo:[0,1,0]
  ds_write_b32 v6, v120 offset:26656
  v_pk_mul_f32 v[72:73], v[110:111], v[110:111] op_sel:[0,0] op_sel_hi:[0,1]
  ds_write_b32 v6, v121 offset:15232
  v_cvt_pk_bf16_f32 v80, v88, v89
  ds_write_b32 v6, v122 offset:15776
  v_cvt_pk_bf16_f32 v81, v92, v93
  ds_write_b32 v6, v123 offset:27200
  v_cvt_pk_bf16_f32 v82, v114, -v115
  v_pk_fma_f32 v[112:113], v[110:111], v[110:111], v[72:73] op_sel:[1,1,0] op_sel_hi:[1,0,1] neg_lo:[0,1,0]
  buffer_load_dwordx4 v29, s[16:19], s59 offen offset:1024 lds
  v_cvt_pk_bf16_f32 v83, v112, -v113
  ds_write_b32 v6, v80 offset:16320
  ds_write_b32 v6, v81 offset:16864
  ds_write_b32 v6, v82 offset:27744
  ds_write_b32 v6, v83 offset:28288
  s_waitcnt lgkmcnt(0)
  s_barrier
  ds_read_b128 v[160:163], v232 offset:0
  ds_read_b128 v[176:179], v233 offset:17408
  ds_read_b128 v[180:183], v233 offset:26112
  ds_read_b128 v[164:167], v232 offset:64
  ds_read_b128 v[184:187], v233 offset:17472
  ds_read_b128 v[188:191], v233 offset:26176
  ds_read_b128 v[168:171], v232 offset:128
  ds_read_b128 v[192:195], v233 offset:17536
  ds_read_b128 v[196:199], v233 offset:26240
  ds_read_b128 v[172:175], v232 offset:192
  ds_read_b128 v[200:203], v233 offset:17600
  ds_read_b128 v[204:207], v233 offset:26304
  v_add_u32 v224, v239, v224
  v_add_u32 v225, v239, v225
  v_add_u32 v226, v239, v226
  v_add_u32 v227, v239, v227
  v_mov_b32 v220, 0
  v_mov_b32 v221, 0
  v_mov_b32 v222, 0
  v_mov_b32 v223, 0
  s_waitcnt lgkmcnt(10)
  v_mfma_f32_16x16x32_bf16 v[208:211], v[160:163], v[176:179], 0
  s_waitcnt lgkmcnt(9)
  v_mfma_f32_16x16x32_bf16 v[212:215], v[160:163], v[180:183], 0
  s_waitcnt lgkmcnt(7)
  v_mfma_f32_16x16x32_bf16 v[208:211], v[164:167], v[184:187], v[208:211]
  s_waitcnt lgkmcnt(6)
  v_mfma_f32_16x16x32_bf16 v[212:215], v[164:167], v[188:191], v[212:215]
  s_waitcnt lgkmcnt(4)
  v_mfma_f32_16x16x32_bf16 v[208:211], v[168:171], v[192:195], v[208:211]
  s_waitcnt lgkmcnt(3)
  v_mfma_f32_16x16x32_bf16 v[212:215], v[168:171], v[196:199], v[212:215]
  s_waitcnt lgkmcnt(1)
  v_mfma_f32_16x16x32_bf16 v[208:211], v[172:175], v[200:203], v[208:211]
  s_waitcnt lgkmcnt(0)
  v_mfma_f32_16x16x32_bf16 v[212:215], v[172:175], v[204:207], v[212:215]
  ds_read_b128 v[160:163], v232 offset:256
  ds_read_b128 v[176:179], v233 offset:17664
  ds_read_b128 v[180:183], v233 offset:26368
  ds_read_b128 v[164:167], v232 offset:320
  ds_read_b128 v[184:187], v233 offset:17728
  ds_read_b128 v[188:191], v233 offset:26432
  ds_read_b128 v[168:171], v232 offset:384
  ds_read_b128 v[192:195], v233 offset:17792
  ds_read_b128 v[196:199], v233 offset:26496
  ds_read_b128 v[172:175], v232 offset:448
  ds_read_b128 v[200:203], v233 offset:17856
  ds_read_b128 v[204:207], v233 offset:26560
  s_waitcnt lgkmcnt(10)
  v_mfma_f32_16x16x32_bf16 v[208:211], v[160:163], v[176:179], v[208:211]
  s_waitcnt lgkmcnt(9)
  v_mfma_f32_16x16x32_bf16 v[212:215], v[160:163], v[180:183], v[212:215]
  s_waitcnt lgkmcnt(7)
  v_mfma_f32_16x16x32_bf16 v[208:211], v[164:167], v[184:187], v[208:211]
  s_waitcnt lgkmcnt(6)
  v_mfma_f32_16x16x32_bf16 v[212:215], v[164:167], v[188:191], v[212:215]
  s_waitcnt lgkmcnt(4)
  v_mfma_f32_16x16x32_bf16 v[208:211], v[168:171], v[192:195], v[208:211]
  s_waitcnt lgkmcnt(3)
  v_mfma_f32_16x16x32_bf16 v[212:215], v[168:171], v[196:199], v[212:215]
  s_waitcnt lgkmcnt(1)
  v_mfma_f32_16x16x32_bf16 v[208:211], v[172:175], v[200:203], v[208:211]
  s_waitcnt lgkmcnt(0)
  v_mfma_f32_16x16x32_bf16 v[212:215], v[172:175], v[204:207], v[212:215]
  ds_write_b32 v239, v220
  s_nop 4
  v_cvt_pk_bf16_f32 v216, v208, v208
  v_cvt_pk_bf16_f32 v217, v209, v209
  v_cvt_pk_bf16_f32 v218, v210, v210
  v_cvt_pk_bf16_f32 v219, v211, v211
  ds_write_b16 v235, v216
  v_add_u32 v235, v234, v235
  ds_write_b16 v235, v217
  v_add_u32 v235, v234, v235
  ds_write_b16 v235, v218
  v_add_u32 v235, v234, v235
  ds_write_b16 v235, v219
  v_cvt_pk_bf16_f32 v216, v212, v212
  v_cvt_pk_bf16_f32 v217, v213, v213
  v_cvt_pk_bf16_f32 v218, v214, v214
  v_cvt_pk_bf16_f32 v219, v215, v215
  ds_write_b16 v237, v216
  v_add_u32 v237, v236, v237
  ds_write_b16 v237, v217
  v_add_u32 v237, v236, v237
  ds_write_b16 v237, v218
  v_add_u32 v237, v236, v237
  ds_write_b16 v237, v219
  s_waitcnt lgkmcnt(0)
  s_barrier
  ds_read2_b32 v[160:161], v240 offset0:32 offset1:33
  ds_read2_b32 v[162:163], v240 offset0:0 offset1:1
  ds_read2_b32 v[164:165], v241 offset0:0 offset1:1
  ds_read2_b32 v[166:167], v224 offset0:0 offset1:1
  ds_read2_b32 v[168:169], v225 offset0:0 offset1:1
  ds_read2_b32 v[170:171], v226 offset0:0 offset1:1
  ds_read2_b32 v[172:173], v227 offset0:0 offset1:1
  ds_write_b128 v245, v[220:223] offset:4096
  s_waitcnt lgkmcnt(7)
  v_perm_b32 v176, v161, v160, v242
  v_perm_b32 v177, v161, v160, v243
  v_perm_b32 v178, v161, v160, v244
  v_perm_b32 v179, v161, v160, v244
  ds_write_b128 v238, v[176:179] offset:0
  s_waitcnt lgkmcnt(7)
  v_perm_b32 v180, v163, v162, v242
  v_perm_b32 v181, v163, v162, v243
  v_perm_b32 v182, v163, v162, v244
  v_perm_b32 v183, v163, v162, v244
  ds_write_b128 v238, v[180:183] offset:1024
  s_waitcnt lgkmcnt(7)
  v_perm_b32 v184, v165, v164, s66
  v_perm_b32 v185, v165, v164, s67
  v_perm_b32 v186, v165, v164, s68
  v_perm_b32 v187, v165, v164, s69
  ds_write_b128 v238, v[184:187] offset:2048
  s_waitcnt lgkmcnt(7)
  v_perm_b32 v188, v167, v166, v228
  s_waitcnt lgkmcnt(6)
  v_perm_b32 v189, v169, v168, v229
  s_waitcnt lgkmcnt(5)
  v_perm_b32 v190, v171, v170, v230
  s_waitcnt lgkmcnt(4)
  v_perm_b32 v191, v173, v172, v231
  ds_write_b128 v238, v[188:191] offset:3072
  s_add_u32 m0, s93, 2048
  s_add_u32 s59, s92, 81920
  buffer_load_dwordx4 v28, s[16:19], s59 offen lds
  buffer_load_dwordx4 v29, s[16:19], s59 offen offset:1024 lds
  s_add_u32 m0, s93, 4096
  s_add_u32 s59, s92, 98304
  buffer_load_dwordx4 v28, s[16:19], s59 offen lds
  buffer_load_dwordx4 v29, s[16:19], s59 offen offset:1024 lds
  s_add_u32 m0, s93, 6144
  s_add_u32 s59, s92, 114688
  buffer_load_dwordx4 v28, s[16:19], s59 offen lds
  buffer_load_dwordx4 v29, s[16:19], s59 offen offset:1024 lds
  s_add_u32 m0, s93, 32768
  s_add_u32 s59, s92, 131072
  buffer_load_dwordx4 v28, s[16:19], s59 offen lds
  s_waitcnt vmcnt(17)
  v_cmp_ne_u32 vcc, s47, v60
  s_cbranch_vccnz Lslow_20
Lback_21:
  s_lshl_b32 s53, s45, 2
  s_lshr_b32 s54, s46, 3
  s_add_u32 s53, s53, s54
  s_lshl_b32 s53, s53, 16
  s_lshl_b32 s54, s46, 1
  s_and_b32 s54, s54, 15
  s_lshl_b32 s54, s54, 4
  s_add_u32 s53, s53, s54
  s_lshl_b32 s54, s44, 13
  s_add_u32 s53, s53, s54
  v_lshrrev_b32 v2, 1, v1
  v_and_b32 v3, 1, v1
  v_lshlrev_b32 v4, 8, v2
  v_lshl_add_u32 v4, v3, 4, v4
  v_add_u32 v4, s53, v4
  global_load_dwordx4 v[216:219], v4, s[20:21] sc1
  v_add_u32 v4, 32768, v4
  global_load_dwordx4 v[220:223], v4, s[20:21] sc1
  v_mul_u32_u24 v3, 4608, v3
  v_lshl_add_u32 v3, v2, 4, v3
  s_lshl_b32 s54, s44, 9
  s_add_u32 s54, s54, 115424
  v_add_u32 v19, s54, v3
  s_waitcnt vmcnt(1)
  ds_write_b128 v19, v[216:219]
  s_waitcnt vmcnt(0)
  ds_write_b128 v19, v[220:223] offset:2048
  v_mov_b32 v160, 0
  v_mov_b32 v161, 0
  v_mov_b32 v162, 0
  v_mov_b32 v163, 0
  s_mul_i32 s54, s57, 4608
  s_add_u32 s54, s54, 114944
  v_lshlrev_b32 v2, 4, v1
  v_add_u32 v2, s54, v2
  s_mov_b64 s[88:89], exec
  s_mov_b64 exec, 0x3fffffff
  ds_write_b128 v2, v[160:163]
  s_mov_b64 exec, s[88:89]
  s_waitcnt vmcnt(0) lgkmcnt(0)
  v_and_b32 v2, 15, v1
  v_lshrrev_b32 v3, 4, v1
  v_and_b32 v4, 14, v2
  v_lshlrev_b32 v5, 3, v3
  v_sub_u32 v5, v5, v4
  v_lshlrev_b32 v5, 1, v5
  v_and_b32 v4, 1, v2
  v_xor_b32 v4, 1, v4
  v_mul_u32_u24 v4, 4160, v4
  v_add_u32 v5, v5, v4
  s_mul_i32 s53, s57, 8320
  s_lshl_b32 s54, s58, 8
  s_sub_u32 s53, s53, s54
  s_add_u32 s53, s53, 101852
  v_add_u32 v20, s53, v5
  s_sub_u32 s53, s53, 1024
  v_add_u32 v21, s53, v5
  s_sub_u32 s53, s53, 1024
  v_add_u32 v22, s53, v5
  s_sub_u32 s53, s53, 1024
  v_add_u32 v23, s53, v5
  v_lshlrev_b32 v4, 5, v2
  v_lshl_add_u32 v4, v3, 4, v4
  s_mul_i32 s53, s57, 4608
  s_lshl_b32 s54, s58, 8
  s_sub_u32 s53, s53, s54
  s_add_u32 s53, s53, 115200
  v_add_u32 v24, s53, v4
  v_and_b32 v2, 15, v1
  v_lshrrev_b32 v3, 4, v1
  v_lshl_add_u32 v4, v2, 2, v3
  v_lshrrev_b32 v5, 3, v4
  v_and_b32 v5, 3, v5
  v_xor_b32 v4, v4, v5
  v_lshlrev_b32 v4, 4, v4
  s_lshl_b32 s53, s44, 13
  s_add_u32 s53, s53, 124160
  v_add_u32 v25, s53, v4
  v_lshlrev_b32 v4, 1, v1
  v_lshrrev_b32 v5, 3, v4
  v_and_b32 v5, 3, v5
  v_xor_b32 v2, v4, v5
  v_lshlrev_b32 v2, 4, v2
  v_xor_b32 v3, 16, v2
  s_lshl_b32 s53, s57, 14
  s_lshl_b32 s54, s58, 12
  s_add_u32 s53, s53, s54
  s_add_u32 s53, s53, 124160
  v_add_u32 v26, s53, v2
  v_add_u32 v27, s53, v3
  s_mul_i32 s53, s57, 4608
  s_lshl_b32 s54, s58, 11
  s_add_u32 s53, s53, s54
  s_add_u32 s53, s53, 115424
  v_lshlrev_b32 v2, 4, v1
  v_add_u32 v58, s53, v2
  s_lshl_b32 s53, s3, 12
  s_lshl_b32 s54, s58, 11
  s_add_u32 s53, s53, s54
  s_add_u32 s53, s53, 0x200000
  v_add_u32 v59, s53, v2
  s_branch Lcommon
  s_waitcnt vmcnt(0) lgkmcnt(0)
Lslow_2:
  s_waitcnt vmcnt(0) lgkmcnt(0)
  s_mov_b32 s62, 0
Lpoll_22:
  global_load_dword v60, v61, s[20:21] sc1
  s_add_u32 s62, s62, 1
  s_waitcnt vmcnt(0)
  v_cmp_ne_u32 vcc, s47, v60
  s_cmp_gt_u32 s62, 262144
  s_cbranch_scc1 Lback_3
  s_cbranch_vccnz Lpoll_22
  s_branch Lback_3
Lslow_5:
  s_waitcnt vmcnt(0) lgkmcnt(0)
  s_mov_b32 s62, 0
Lpoll_23:
  global_load_dword v60, v61, s[20:21] sc1
  s_add_u32 s62, s62, 1
  s_waitcnt vmcnt(0)
  v_cmp_ne_u32 vcc, s47, v60
  s_cmp_gt_u32 s62, 262144
  s_cbranch_scc1 Lback_6
  s_cbranch_vccnz Lpoll_23
  s_branch Lback_6
Lslow_8:
  s_waitcnt vmcnt(0) lgkmcnt(0)
  s_mov_b32 s62, 0
Lpoll_24:
  global_load_dword v24, v23, s[20:21] sc1
  s_add_u32 s62, s62, 1
  s_waitcnt vmcnt(0)
  v_cmp_ne_u32 vcc, s47, v24
  s_cmp_gt_u32 s62, 262144
  s_cbranch_scc1 Lback_9
  s_cbranch_vccnz Lpoll_24
  s_branch Lback_9
Lslow_16:
  s_waitcnt vmcnt(0) lgkmcnt(0)
  s_mov_b32 s62, 0
Lpoll_25:
  global_load_dwordx4 v[28:31], v25, s[20:21] sc1
  s_add_u32 s62, s62, 1
  s_waitcnt vmcnt(0)
  v_cmp_ne_u32 vcc, s47, v28
  v_cmp_ne_u32 s[94:95], s47, v29
  s_nop 0
  s_or_b64 vcc, vcc, s[94:95]
  v_cmp_ne_u32 s[94:95], s47, v30
  s_nop 0
  s_or_b64 vcc, vcc, s[94:95]
  v_cmp_ne_u32 s[94:95], s47, v31
  s_nop 0
  s_or_b64 vcc, vcc, s[94:95]
  s_cmp_gt_u32 s62, 262144
  s_cbranch_scc1 Lback_17
  s_cbranch_vccnz Lpoll_25
  s_branch Lback_17
Lslow_20:
  s_waitcnt vmcnt(0) lgkmcnt(0)
  s_mov_b32 s62, 0
Lpoll_26:
  global_load_dword v60, v61, s[20:21] sc1
  s_add_u32 s62, s62, 1
  s_waitcnt vmcnt(0)
  v_cmp_ne_u32 vcc, s47, v60
  s_cmp_gt_u32 s62, 262144
  s_cbranch_scc1 Lback_21
  s_cbranch_vccnz Lpoll_26
  s_branch Lback_21
.p2align 7
Ltable:
  .long 0x300, 0x300, 0x2fc, 0x2fc, 0x2f8, 0x2f8, 0x2f4, 0x2f4
  .long 0x2f0, 0x2f0, 0x2ec, 0x2ec, 0x2e8, 0x2e8, 0x2e4, 0x2e4
  .long 0x2e0, 0x2e0, 0x2dc, 0x2dc, 0x2d8, 0x2d8, 0x2d4, 0x2d4
  .long 0x2d0, 0x2d0, 0x2cc, 0x2cc, 0x2c8, 0x2c8, 0x2c4, 0x2c4
  .long 0x2c0, 0x2c0, 0x2bc, 0x2bc, 0x2b8, 0x2b8, 0x2b4, 0x2b4
  .long 0x2b0, 0x2b0, 0x2ac, 0x2ac, 0x2a8, 0x2a8, 0x2a4, 0x2a4
  .long 0x2a0, 0x2a0, 0x29c, 0x29c, 0x298, 0x298, 0x294, 0x294
  .long 0x290, 0x290, 0x28c, 0x28c, 0x288, 0x288, 0x284, 0x284
  .long 0x280, 0x280, 0x27c, 0x27c, 0x278, 0x278, 0x274, 0x274
  .long 0x270, 0x270, 0x26c, 0x26c, 0x268, 0x268, 0x264, 0x264
  .long 0x260, 0x260, 0x25c, 0x25c, 0x258, 0x258, 0x254, 0x254
  .long 0x250, 0x250, 0x24c, 0x24c, 0x248, 0x248, 0x244, 0x244
  .long 0x240, 0x240, 0x23c, 0x23c, 0x238, 0x238, 0x234, 0x234
  .long 0x230, 0x230, 0x22c, 0x22c, 0x228, 0x228, 0x224, 0x224
  .long 0x220, 0x220, 0x21c, 0x21c, 0x218, 0x218, 0x214, 0x214
  .long 0x210, 0x210, 0x20c, 0x20c, 0x208, 0x208, 0x204, 0x204
  .long 0x200, 0x1fc, 0x1f8, 0x1f4, 0x1f0, 0x1ec, 0x1e8, 0x1e4
  .long 0x1e0, 0x1dc, 0x1d8, 0x1d4, 0x1d0, 0x1cc, 0x1c8, 0x1c4
  .long 0x1c0, 0x1bc, 0x1b8, 0x1b4, 0x1b0, 0x1ac, 0x1a8, 0x1a4
  .long 0x1a0, 0x19c, 0x198, 0x194, 0x190, 0x18c, 0x188, 0x184
  .long 0x180, 0x17c, 0x178, 0x174, 0x170, 0x16c, 0x168, 0x164
  .long 0x160, 0x15c, 0x158, 0x154, 0x150, 0x14c, 0x148, 0x144
  .long 0x140, 0x13c, 0x138, 0x134, 0x130, 0x12c, 0x128, 0x124
  .long 0x120, 0x11c, 0x118, 0x114, 0x110, 0x10c, 0x108, 0x104
  .long 0x100, 0xfc, 0xf8, 0xf4, 0xf0, 0xec, 0xe8, 0xe4
  .long 0xe0, 0xdc, 0xd8, 0xd4, 0xd0, 0xcc, 0xc8, 0xc4
  .long 0xc0, 0xbc, 0xb8, 0xb4, 0xb0, 0xac, 0xa8, 0xa4
  .long 0xa0, 0x9c, 0x98, 0x94, 0x90, 0x8c, 0x88, 0x84
  .long 0x80, 0x7c, 0x78, 0x74, 0x70, 0x6c, 0x68, 0x64
  .long 0x60, 0x5c, 0x58, 0x54, 0x50, 0x4c, 0x48, 0x44
  .long 0x40, 0x3c, 0x38, 0x34, 0x30, 0x2c, 0x28, 0x24
  .long 0x20, 0x1c, 0x18, 0x14, 0x10, 0xc, 0x8, 0x4
  .long 0x3020504, 0x1000100, 0x3020504, 0x1000100, 0x3020504, 0x1000100, 0x3020504, 0x1000100
  .long 0x3020504, 0x1000100, 0x3020504, 0x1000100, 0x3020504, 0x1000100, 0x3020504, 0x1000100
  .long 0x3020504, 0x1000100, 0x3020504, 0x1000100, 0x3020504, 0x1000100, 0x3020504, 0x1000100
  .long 0x3020504, 0x1000100, 0x3020504, 0x1000100, 0x3020504, 0x1000100, 0x3020504, 0x1000100
  .long 0x3020504, 0x1000100, 0x3020504, 0x1000100, 0x3020504, 0x1000100, 0x3020504, 0x1000100
  .long 0x3020504, 0x1000100, 0x3020504, 0x1000100, 0x3020504, 0x1000100, 0x3020504, 0x1000100
  .long 0x3020504, 0x1000100, 0x3020504, 0x1000100, 0x3020504, 0x1000100, 0x3020504, 0x1000100
  .long 0x3020504, 0x1000100, 0x3020504, 0x1000100, 0x3020504, 0x1000100, 0x3020504, 0x1000100
  .long 0x3020504, 0x1000100, 0x3020504, 0x1000100, 0x3020504, 0x1000100, 0x3020504, 0x1000100
  .long 0x3020504, 0x1000100, 0x3020504, 0x1000100, 0x3020504, 0x1000100, 0x3020504, 0x1000100
  .long 0x3020504, 0x1000100, 0x3020504, 0x1000100, 0x3020504, 0x1000100, 0x3020504, 0x1000100
  .long 0x3020504, 0x1000100, 0x3020504, 0x1000100, 0x3020504, 0x1000100, 0x3020504, 0x1000100
  .long 0x3020504, 0x1000100, 0x3020504, 0x1000100, 0x3020504, 0x1000100, 0x3020504, 0x1000100
  .long 0x3020504, 0x1000100, 0x3020504, 0x1000100, 0x3020504, 0x1000100, 0x3020504, 0x1000100
  .long 0x3020504, 0x1000100, 0x3020504, 0x1000100, 0x3020504, 0x1000100, 0x3020504, 0x1000100
  .long 0x3020504, 0x1000100, 0x3020504, 0x1000100, 0x3020504, 0x1000100, 0x3020504, 0x1000100
  .long 0x1000302, 0x1000302, 0x1000302, 0x1000302, 0x1000302, 0x1000302, 0x1000302, 0x1000302
  .long 0x1000302, 0x1000302, 0x1000302, 0x1000302, 0x1000302, 0x1000302, 0x1000302, 0x1000302
  .long 0x1000302, 0x1000302, 0x1000302, 0x1000302, 0x1000302, 0x1000302, 0x1000302, 0x1000302
  .long 0x1000302, 0x1000302, 0x1000302, 0x1000302, 0x1000302, 0x1000302, 0x1000302, 0x1000302
  .long 0x1000302, 0x1000302, 0x1000302, 0x1000302, 0x1000302, 0x1000302, 0x1000302, 0x1000302
  .long 0x1000302, 0x1000302, 0x1000302, 0x1000302, 0x1000302, 0x1000302, 0x1000302, 0x1000302
  .long 0x1000302, 0x1000302, 0x1000302, 0x1000302, 0x1000302, 0x1000302, 0x1000302, 0x1000302
  .long 0x1000302, 0x1000302, 0x1000302, 0x1000302, 0x1000302, 0x1000302, 0x1000302, 0x1000302
  .long 0x1000302, 0x1000302, 0x1000302, 0x1000302, 0x1000302, 0x1000302, 0x1000302, 0x1000302
  .long 0x1000302, 0x1000302, 0x1000302, 0x1000302, 0x1000302, 0x1000302, 0x1000302, 0x1000302
  .long 0x1000302, 0x1000302, 0x1000302, 0x1000302, 0x1000302, 0x1000302, 0x1000302, 0x1000302
  .long 0x1000302, 0x1000302, 0x1000302, 0x1000302, 0x1000302, 0x1000302, 0x1000302, 0x1000302
  .long 0x1000302, 0x1000302, 0x1000302, 0x1000302, 0x1000302, 0x1000302, 0x1000302, 0x1000302
  .long 0x1000302, 0x1000302, 0x1000302, 0x1000302, 0x1000302, 0x1000302, 0x1000302, 0x1000302
  .long 0x1000302, 0x1000302, 0x1000302, 0x1000302, 0x1000302, 0x1000302, 0x1000302, 0x1000302
  .long 0x1000302, 0x1000302, 0x1000302, 0x1000302, 0x1000302, 0x1000302, 0x1000302, 0x1000302
  .long 0x300, 0x300, 0x2fc, 0x2fc, 0x2f8, 0x2f8, 0x2f4, 0x2f4
  .long 0x2f0, 0x2f0, 0x2ec, 0x2ec, 0x2e8, 0x2e8, 0x2e4, 0x2e4
  .long 0x2e0, 0x2e0, 0x2dc, 0x2dc, 0x2d8, 0x2d8, 0x2d4, 0x2d4
  .long 0x2d0, 0x2d0, 0x2cc, 0x2cc, 0x2c8, 0x2c8, 0x2c4, 0x2c4
  .long 0x2c0, 0x2c0, 0x2bc, 0x2bc, 0x2b8, 0x2b8, 0x2b4, 0x2b4
  .long 0x2b0, 0x2b0, 0x2ac, 0x2ac, 0x2a8, 0x2a8, 0x2a4, 0x2a4
  .long 0x2a0, 0x2a0, 0x29c, 0x29c, 0x298, 0x298, 0x294, 0x294
  .long 0x290, 0x290, 0x28c, 0x28c, 0x288, 0x288, 0x284, 0x284
  .long 0x280, 0x280, 0x27c, 0x27c, 0x278, 0x278, 0x274, 0x274
  .long 0x270, 0x270, 0x26c, 0x26c, 0x268, 0x268, 0x264, 0x264
  .long 0x260, 0x260, 0x25c, 0x25c, 0x258, 0x258, 0x254, 0x254
  .long 0x250, 0x250, 0x24c, 0x24c, 0x248, 0x248, 0x244, 0x244
  .long 0x240, 0x240, 0x23c, 0x23c, 0x238, 0x238, 0x234, 0x234
  .long 0x230, 0x230, 0x22c, 0x22c, 0x228, 0x228, 0x224, 0x224
  .long 0x220, 0x220, 0x21c, 0x21c, 0x218, 0x218, 0x214, 0x214
  .long 0x210, 0x210, 0x20c, 0x20c, 0x208, 0x208, 0x204, 0x200
  .long 0x1fc, 0x1f8, 0x1f4, 0x1f0, 0x1ec, 0x1e8, 0x1e4, 0x1e0
  .long 0x1dc, 0x1d8, 0x1d4, 0x1d0, 0x1cc, 0x1c8, 0x1c4, 0x1c0
  .long 0x1bc, 0x1b8, 0x1b4, 0x1b0, 0x1ac, 0x1a8, 0x1a4, 0x1a0
  .long 0x19c, 0x198, 0x194, 0x190, 0x18c, 0x188, 0x184, 0x180
  .long 0x17c, 0x178, 0x174, 0x170, 0x16c, 0x168, 0x164, 0x160
  .long 0x15c, 0x158, 0x154, 0x150, 0x14c, 0x148, 0x144, 0x140
  .long 0x13c, 0x138, 0x134, 0x130, 0x12c, 0x128, 0x124, 0x120
  .long 0x11c, 0x118, 0x114, 0x110, 0x10c, 0x108, 0x104, 0x100
  .long 0xfc, 0xf8, 0xf4, 0xf0, 0xec, 0xe8, 0xe4, 0xe0
  .long 0xdc, 0xd8, 0xd4, 0xd0, 0xcc, 0xc8, 0xc4, 0xc0
  .long 0xbc, 0xb8, 0xb4, 0xb0, 0xac, 0xa8, 0xa4, 0xa0
  .long 0x9c, 0x98, 0x94, 0x90, 0x8c, 0x88, 0x84, 0x80
  .long 0x7c, 0x78, 0x74, 0x70, 0x6c, 0x68, 0x64, 0x60
  .long 0x5c, 0x58, 0x54, 0x50, 0x4c, 0x48, 0x44, 0x40
  .long 0x3c, 0x38, 0x34, 0x30, 0x2c, 0x28, 0x24, 0x20
  .long 0x1c, 0x18, 0x14, 0x10, 0xc, 0x8, 0x4, 0x0
  .long 0x1000302, 0x1000100, 0x1000302, 0x1000100, 0x1000302, 0x1000100, 0x1000302, 0x1000100
  .long 0x1000302, 0x1000100, 0x1000302, 0x1000100, 0x1000302, 0x1000100, 0x1000302, 0x1000100
  .long 0x1000302, 0x1000100, 0x1000302, 0x1000100, 0x1000302, 0x1000100, 0x1000302, 0x1000100
  .long 0x1000302, 0x1000100, 0x1000302, 0x1000100, 0x1000302, 0x1000100, 0x1000302, 0x1000100
  .long 0x1000302, 0x1000100, 0x1000302, 0x1000100, 0x1000302, 0x1000100, 0x1000302, 0x1000100
  .long 0x1000302, 0x1000100, 0x1000302, 0x1000100, 0x1000302, 0x1000100, 0x1000302, 0x1000100
  .long 0x1000302, 0x1000100, 0x1000302, 0x1000100, 0x1000302, 0x1000100, 0x1000302, 0x1000100
  .long 0x1000302, 0x1000100, 0x1000302, 0x1000100, 0x1000302, 0x1000100, 0x1000302, 0x1000100
  .long 0x1000302, 0x1000100, 0x1000302, 0x1000100, 0x1000302, 0x1000100, 0x1000302, 0x1000100
  .long 0x1000302, 0x1000100, 0x1000302, 0x1000100, 0x1000302, 0x1000100, 0x1000302, 0x1000100
  .long 0x1000302, 0x1000100, 0x1000302, 0x1000100, 0x1000302, 0x1000100, 0x1000302, 0x1000100
  .long 0x1000302, 0x1000100, 0x1000302, 0x1000100, 0x1000302, 0x1000100, 0x1000302, 0x1000100
  .long 0x1000302, 0x1000100, 0x1000302, 0x1000100, 0x1000302, 0x1000100, 0x1000302, 0x1000100
  .long 0x1000302, 0x1000100, 0x1000302, 0x1000100, 0x1000302, 0x1000100, 0x1000302, 0x1000100
  .long 0x1000302, 0x1000100, 0x1000302, 0x1000100, 0x1000302, 0x1000100, 0x1000302, 0x1000100
  .long 0x1000302, 0x1000100, 0x1000302, 0x1000100, 0x1000302, 0x1000100, 0x1000302, 0x3020504
  .long 0x3020504, 0x3020504, 0x3020504, 0x3020504, 0x3020504, 0x3020504, 0x3020504, 0x3020504
  .long 0x3020504, 0x3020504, 0x3020504, 0x3020504, 0x3020504, 0x3020504, 0x3020504, 0x3020504
  .long 0x3020504, 0x3020504, 0x3020504, 0x3020504, 0x3020504, 0x3020504, 0x3020504, 0x3020504
  .long 0x3020504, 0x3020504, 0x3020504, 0x3020504, 0x3020504, 0x3020504, 0x3020504, 0x3020504
  .long 0x3020504, 0x3020504, 0x3020504, 0x3020504, 0x3020504, 0x3020504, 0x3020504, 0x3020504
  .long 0x3020504, 0x3020504, 0x3020504, 0x3020504, 0x3020504, 0x3020504, 0x3020504, 0x3020504
  .long 0x3020504, 0x3020504, 0x3020504, 0x3020504, 0x3020504, 0x3020504, 0x3020504, 0x3020504
  .long 0x3020504, 0x3020504, 0x3020504, 0x3020504, 0x3020504, 0x3020504, 0x3020504, 0x3020504
  .long 0x3020504, 0x3020504, 0x3020504, 0x3020504, 0x3020504, 0x3020504, 0x3020504, 0x3020504
  .long 0x3020504, 0x3020504, 0x3020504, 0x3020504, 0x3020504, 0x3020504, 0x3020504, 0x3020504
  .long 0x3020504, 0x3020504, 0x3020504, 0x3020504, 0x3020504, 0x3020504, 0x3020504, 0x3020504
  .long 0x3020504, 0x3020504, 0x3020504, 0x3020504, 0x3020504, 0x3020504, 0x3020504, 0x3020504
  .long 0x3020504, 0x3020504, 0x3020504, 0x3020504, 0x3020504, 0x3020504, 0x3020504, 0x3020504
  .long 0x3020504, 0x3020504, 0x3020504, 0x3020504, 0x3020504, 0x3020504, 0x3020504, 0x3020504
  .long 0x3020504, 0x3020504, 0x3020504, 0x3020504, 0x3020504, 0x3020504, 0x3020504, 0x3020504
  .long 0x3020504, 0x3020504, 0x3020504, 0x3020504, 0x3020504, 0x3020504, 0x3020504, 0x3020504
Lcode_end:
.section .rodata,"a"
.p2align 6
.amdhsa_kernel gated_mix__ssm_conv_s4__dense_activation_mish__prompt_kernel
  .amdhsa_next_free_vgpr 512
  .amdhsa_next_free_sgpr 102
  .amdhsa_accum_offset 256
  .amdhsa_group_segment_fixed_size 0
  .amdhsa_kernarg_size 136
  .amdhsa_user_sgpr_count 2
  .amdhsa_user_sgpr_kernarg_segment_ptr 1
  .amdhsa_system_sgpr_workgroup_id_x 1
  .amdhsa_float_denorm_mode_32 3
.end_amdhsa_kernel
```
